```python
import torch

def _softmax(x, axis=-1):
    return torch.softmax(x, dim=axis)
def _gelu(x):
    return torch.nn.functional.gelu(x, approximate="tanh")
def _silu(x):
    return torch.nn.functional.silu(x)
def _sigmoid(x):
    return torch.sigmoid(x)
def _layernorm(x, axis=-1, eps=1e-5):
    m = x.mean(dim=axis, keepdim=True)
    v = x.var(dim=axis, keepdim=True, unbiased=False)
    return (x - m) / torch.sqrt(v + eps)
def _scatter_add(tgt, idx, src, axis=0):
    return tgt.clone().index_add_(axis, idx, src)
def _segment_sum(src, seg, n):
    out = torch.zeros((n,) + src.shape[1:], dtype=src.dtype)
    return out.index_add_(0, seg, src)
def _pad(x, pw):
    flat = tuple(v for pair in reversed(pw) for v in pair)
    return torch.nn.functional.pad(x, flat)

kernel_name = 'gated_mix__ssm_conv_h3__mha_block__prompt'

def setup_inputs():

    _w = (lambda a: (lambda t: t.to(torch.bfloat16) if t.is_floating_point() else t)(torch.as_tensor(a)))
    def _A_setup():
        B, S, D = 1, 2048, 448
        ks = 4
        return {
            "q": _w((lambda *s: torch.randn(*s, dtype=torch.bfloat16) * 0.05)(B, S, D)),
            "k": _w((lambda *s: torch.randn(*s, dtype=torch.bfloat16) * 0.4)(B, S, D)),
            "v": _w((lambda *s: torch.randn(*s, dtype=torch.bfloat16) * 0.4)(B, S, D)),
            "shift_k": _w((lambda *s: torch.randn(*s, dtype=torch.bfloat16) * 0.4)(D, ks) * 0.5),
            "ssm_k": _w((lambda *s: torch.randn(*s, dtype=torch.bfloat16) * 0.8)(D, S) * (1.0 / S ** 0.5)),
            "ssm_D": _w((lambda *s: torch.randn(*s, dtype=torch.bfloat16) * 0.4)(D)),
        }
    _A_in = _A_setup()

    def _B_setup():
        B, S, D, H = 1, 2048, 448, 16
        return {
            "x": _w((lambda *s: torch.randn(*s, dtype=torch.bfloat16) * 0.05)(B, S, D)),
            "wqkv": _w((lambda *s: torch.randn(*s, dtype=torch.bfloat16) * 0.8)(D, 3 * D)),
            "wo": _w((lambda *s: torch.randn(*s, dtype=torch.bfloat16) * 0.05)(D, D)),
        }
    _B_in = _B_setup()

    return {
        "A_q": _A_in["q"],
        "A_k": _A_in["k"],
        "A_v": _A_in["v"],
        "A_shift_k": _A_in["shift_k"],
        "A_ssm_k": _A_in["ssm_k"],
        "A_ssm_D": _A_in["ssm_D"],
        "B_x": _B_in["x"],
        "B_wqkv": _B_in["wqkv"],
        "B_wo": _B_in["wo"],
        "gate_w": _w((lambda *s: torch.randn(*s, dtype=torch.bfloat16) * 0.05)(448) * 16.0),
    }

def reference(A_q, A_k, A_v, A_shift_k, A_ssm_k, A_ssm_D, B_x, B_wqkv, B_wo, gate_w):
    def _A_ref(q, k, v, shift_k, ssm_k, ssm_D):
        B, S, D = q.shape
        ks = shift_k.shape[-1]
        k_pad = _pad(k, ((0, 0), (ks - 1, 0), (0, 0)))
        k_shift = torch.zeros_like(k)
        for t in range(ks):
            k_shift = k_shift + k_pad[:, t:t + S, :] * shift_k[:, ks - 1 - t][None, None, :]
        kv = k_shift * v
        L = 2 * S
        kv_pad = _pad(kv, ((0, 0), (0, S), (0, 0)))
        kf_pad = _pad(ssm_k, ((0, 0), (0, S)))
        kv_f = (lambda x, axes=(-2,-1): torch.fft.rfft2(x.float(), dim=axes))(kv_pad[:, None, :, :], axes=(1, 2))
        kf_f = (lambda x, axes=(-2,-1): torch.fft.rfft2(x.float(), dim=axes))(kf_pad[:, None, :], axes=(1, 2))
        kf_f = (lambda x, *d: x.permute(*d))(kf_f, 1, 2, 0)
        y_f = kv_f * kf_f[None, :, :, :]
        y = (lambda x, s, axes=(-2,-1): torch.fft.irfft2(x, s=s, dim=axes).to(torch.bfloat16))(y_f, (1, L), axes=(1, 2))[:, 0, :S, :]
        y = y + kv * ssm_D[None, None, :]
        return q * y

    def _B_ref(x, wqkv, wo):
        B, S, D = x.shape
        H = 16
        Dh = D // H
        qkv = (lambda x, *d: x.permute(*d))((x @ wqkv).reshape(B, S, 3, H, Dh), 2, 0, 3, 1, 4)
        q, k, v = qkv[0], qkv[1], qkv[2]
        scores = torch.einsum("bhqd,bhkd->bhqk", q, k) * (Dh ** -0.5)
        p = _softmax(scores, axis=-1)
        o = torch.einsum("bhqk,bhkd->bhqd", p, v)
        return (lambda x, *d: x.permute(*d))(o, 0, 2, 1, 3).reshape(B, S, D) @ wo

    x = A_q
    g = _sigmoid((x * gate_w).sum(-1, keepdims=True))
    a = _A_ref(x, A_k, A_v, A_shift_k, A_ssm_k, A_ssm_D)
    b = _B_ref(x, B_wqkv, B_wo)
    return g * a + (1 - g) * b
```

```asm
; @launch grid=(256,1,1) block=(512,1,1) lds=148928
.amdgcn_target "amdgcn-amd-amdhsa--gfx950"
.text
.globl gated_mix__ssm_conv_h3__mha_block__prompt_kernel
.p2align 8
.type gated_mix__ssm_conv_h3__mha_block__prompt_kernel,@function
gated_mix__ssm_conv_h3__mha_block__prompt_kernel:
    s_cmp_ge_u32 s2, 256
    s_cbranch_scc1 L_END
    s_load_dwordx16 s[16:31], s[0:1], 0
    s_load_dwordx8 s[32:39], s[0:1], 64
    s_load_dwordx2 s[40:41], s[0:1], 96
    s_getpc_b64 s[10:11]
L_PC:
    s_sub_u32 s10, s10, L_PC-gated_mix__ssm_conv_h3__mha_block__prompt_kernel
    s_subb_u32 s11, s11, 0
    s_lshr_b32 s7, s2, 3
    s_lshl_b32 s7, s7, 10
    v_lshl_add_u32 v3, v0, 1, s7
    v_and_b32 v3, 0xffffff80, v3
    v_min_u32 v3, L_CODE_END-gated_mix__ssm_conv_h3__mha_block__prompt_kernel-4, v3
    global_load_dword v191, v3, s[10:11]
    v_lshrrev_b32 v2, 6, v0
    v_and_b32 v1, 63, v0
    s_and_b32 s7, s2, 7
    v_readfirstlane_b32 s3, v2
    s_lshr_b32 s8, s2, 3
    s_lshl_b32 s7, s7, 3
    s_mov_b32 s10, 0x5d3e1f00
    s_mov_b32 s11, 0xd9ba9b7c
    s_mov_b32 s12, 0x7c5d3e1f
    s_mov_b32 s13, 0xf2d9ba9b
    s_lshr_b64 s[10:11], s[10:11], s7
    s_lshr_b64 s[12:13], s[12:13], s7
    s_and_b32 s7, s10, 0xff
    s_and_b32 s12, s12, 0xff
    s_add_u32 s7, s7, s8
    s_cmp_lt_u32 s7, s12
    s_cselect_b32 s6, 1, 0
    s_cmp_lt_u32 s7, 132
    s_cselect_b32 s8, 0, 132
    s_movk_i32 s9, 13108
    s_cselect_b32 s9, 10923, s9
    s_cselect_b32 s10, 6, 5
    s_cselect_b32 s11, 0, 6
    s_sub_u32 s7, s7, s8
    s_mul_i32 s4, s7, s9
    s_lshr_b32 s4, s4, 16
    s_mul_i32 s5, s4, s10
    s_sub_u32 s5, s7, s5
    s_add_u32 s5, s5, s11
    s_and_b32 s69, s3, 3
    v_lshlrev_b32 v2, 4, v1
    v_and_b32 v4, 31, v1
    v_lshrrev_b32 v5, 5, v1
    s_and_b32 s71, s2, 7
    s_lshl_b32 s71, s71, 1
    s_bfe_u32 s7, s2, 0x10003
    s_add_u32 s71, s71, s7
    s_lshr_b32 s70, s2, 4
    s_cmp_ge_u32 s3, 4
    s_cbranch_scc1 L_MAIN
    v_lshrrev_b32 v6, 3, v1
    v_lshrrev_b32 v3, 4, v1
    v_mov_b32 v14, 0x7fff0000
    s_and_b32 s95, s69, 1
    s_cmp_ge_u32 s69, 2
    s_cbranch_scc1 L_UPREP
    v_and_b32 v7, 7, v1
    v_xor_b32 v7, v7, v3
    v_mul_u32_u24 v8, 896, v6
    v_lshl_add_u32 v8, v7, 4, v8
    v_xor_b32 v9, 64, v8
    v_and_b32 v7, 15, v1
    v_lshlrev_b32 v11, 2, v3
    v_xor_b32 v7, v7, v11
    v_mul_u32_u24 v10, 2688, v3
    v_lshl_add_u32 v10, v7, 4, v10
    s_cmp_eq_u32 s5, 10
    s_cselect_b32 s7, 8, 16
    v_cmp_gt_u32 vcc, s7, v7
    s_mul_i32 s80, s4, 96
    s_mul_i32 s7, s95, 48
    v_cndmask_b32 v10, v14, v10, vcc
    s_add_u32 s80, s80, s7
    s_mul_i32 s80, s80, 896
    s_lshl_b32 s81, s5, 8
    s_mul_i32 s7, s95, 86016
    s_add_u32 s81, s81, s7
    s_and_b32 s72, s2, 3
    s_mul_i32 s72, s72, 2
    s_bfe_u32 s7, s2, 0x10002
    s_mul_i32 s7, s7, 1
    s_add_u32 s72, s72, s7
    s_add_u32 s7, s4, s5
    s_and_b32 s7, s7, 1
    s_add_u32 s72, s72, s7
    s_mul_i32 s7, s72, 9363
    s_lshr_b32 s7, s7, 16
    s_mul_i32 s7, s7, 7
    s_sub_u32 s72, s72, s7
    s_mul_i32 s75, s95, 6144
    s_lshl_b32 s76, s95, 13
    s_add_u32 s76, s76, 12288
    s_mov_b32 s73, 28672
    s_mov_b32 s74, 0
    s_waitcnt lgkmcnt(0)
    s_mov_b32 s48, s16
    s_mov_b32 s49, s17
    s_mov_b32 s50, 0x1c0000
    s_mov_b32 s51, 0x00020000
    s_mov_b32 s52, s30
    s_mov_b32 s53, s31
    s_mov_b32 s54, 0x126000
    s_mov_b32 s55, 0x00020000
    s_mov_b32 s44, s40
    s_mov_b32 s45, s41
    s_mov_b32 s46, 0xd30000
    s_mov_b32 s47, 0x00020000
    s_cmp_eq_u32 s6, 0
    s_cselect_b32 s50, 0, s50
    s_cselect_b32 s54, 0, s54
    s_min_u32 s7, s2, 223
    s_lshl_b32 s7, s7, 2
    s_load_dword s93, s[26:27], s7
    v_lshlrev_b32 v12, 7, v1
L_H_LOOP:
    s_cmp_lt_u32 s74, 2
    s_cbranch_scc1 L_H_ISSUE
    s_waitcnt vmcnt(14)
    s_barrier
L_H_ISSUE:
    s_add_u32 s8, s73, s75
    s_lshl_b32 s7, s72, 7
    s_add_u32 s7, s7, s80
    s_add_u32 m0, s8, 0
    s_nop 0
    buffer_load_dwordx4 v8, s[48:51], s7 offen offset:0  lds
    s_add_u32 s7, s7, 6144
    buffer_load_dwordx4 v9, s[48:51], s7 offen offset:1024  lds
    s_add_u32 s7, s7, 6144
    buffer_load_dwordx4 v8, s[48:51], s7 offen offset:2048  lds
    s_add_u32 s7, s7, 6144
    buffer_load_dwordx4 v9, s[48:51], s7 offen offset:3072  lds
    s_add_u32 m0, s8, 4096
    s_add_u32 s7, s7, 10240
    buffer_load_dwordx4 v8, s[48:51], s7 offen offset:0  lds
    s_add_u32 s7, s7, 6144
    buffer_load_dwordx4 v9, s[48:51], s7 offen offset:1024  lds
    s_add_u32 s8, s73, s76
    s_mul_i32 s7, s72, 172032
    s_add_u32 s7, s7, s81
    s_add_u32 m0, s8, 0
    s_nop 0
    buffer_load_dwordx4 v10, s[52:55], s7 offen offset:0  lds
    s_add_u32 s7, s7, 9728
    buffer_load_dwordx4 v10, s[52:55], s7 offen offset:1024  lds
    s_add_u32 s7, s7, 9728
    buffer_load_dwordx4 v10, s[52:55], s7 offen offset:2048  lds
    s_add_u32 s7, s7, 9728
    buffer_load_dwordx4 v10, s[52:55], s7 offen offset:3072  lds
    s_add_u32 m0, s8, 4096
    s_add_u32 s7, s7, 13824
    buffer_load_dwordx4 v10, s[52:55], s7 offen offset:0  lds
    s_add_u32 s7, s7, 9728
    buffer_load_dwordx4 v10, s[52:55], s7 offen offset:1024  lds
    s_add_u32 s7, s7, 9728
    buffer_load_dwordx4 v10, s[52:55], s7 offen offset:2048  lds
    s_add_u32 s7, s7, 9728
    buffer_load_dwordx4 v10, s[52:55], s7 offen offset:3072  lds
    s_cmp_eq_u32 s74, 0
    s_cbranch_scc1 L_H_FILT
L_H_FBACK:
    s_add_u32 s72, s72, 1
    s_cmp_eq_u32 s72, 7
    s_cselect_b32 s72, 0, s72
    s_add_u32 s73, s73, 28672
    s_cmp_eq_u32 s73, 114688
    s_cselect_b32 s73, 0, s73
    s_add_u32 s74, s74, 1
    s_cmp_lt_u32 s74, 7
    s_cbranch_scc1 L_H_LOOP
    s_waitcnt vmcnt(14)
    s_barrier
    s_waitcnt vmcnt(0)
    s_barrier
    s_lshr_b32 s7, s69, 1
    s_mul_i32 s8, s7, 4224
    s_lshl_b32 s9, s89, 7
    s_add_u32 s8, s8, s9
    s_add_u32 s8, s8, 140416
    v_add_u32 v174, s8, v2
    ds_read_b128 v[176:179], v174
    ds_read_b128 v[180:183], v174 offset:16
    ds_read_b128 v[184:187], v174 offset:1024
    ds_read_b128 v[188:191], v174 offset:1040
    s_lshl_b32 s7, s7, 4
    s_lshr_b32 s7, s93, s7
    s_lshl_b32 s7, s7, 16
    v_add_u32 v175, s89, v1
    s_waitcnt lgkmcnt(0)
    v_lshlrev_b32 v16, 16, v180
    v_add_f32 v16, s7, v16
    v_and_b32 v17, 0xffff0000, v180
    v_cvt_pk_bf16_f32 v16, v16, v17
    v_cmp_eq_u32 vcc, 0, v175
    s_lshl_b32 s7, s89, 3
    v_add_u32 v17, 3, v1
    v_cndmask_b32 v180, v180, v16, vcc
    v_add_u32 v17, s7, v17
    v_lshrrev_b32 v174, 2, v17
    v_and_b32 v17, 3, v17
    v_mul_u32_u24 v174, 576, v174
    v_lshl_add_u32 v174, v17, 4, v174
    v_add_u32 v174, s91, v174
    v_add_u32 v175, s91, v2
    v_alignbit_b32 v64, v177, v176, 16
    v_alignbit_b32 v65, v178, v177, 16
    v_alignbit_b32 v66, v179, v178, 16
    v_alignbit_b32 v67, v180, v179, 16
    v_alignbit_b32 v68, v181, v180, 16
    v_alignbit_b32 v69, v182, v181, 16
    v_alignbit_b32 v70, v178, v177, 16
    v_alignbit_b32 v71, v179, v178, 16
    v_alignbit_b32 v72, v180, v179, 16
    v_alignbit_b32 v73, v181, v180, 16
    v_alignbit_b32 v74, v182, v181, 16
    v_alignbit_b32 v75, v183, v182, 16
    v_mov_b32 v76, v177
    v_mov_b32 v77, v178
    v_mov_b32 v78, v179
    v_mov_b32 v79, v180
    v_mov_b32 v80, v181
    v_mov_b32 v81, v182
    v_alignbit_b32 v82, v185, v184, 16
    v_alignbit_b32 v83, v186, v185, 16
    v_alignbit_b32 v84, v187, v186, 16
    v_alignbit_b32 v85, v188, v187, 16
    v_alignbit_b32 v86, v189, v188, 16
    v_alignbit_b32 v87, v190, v189, 16
    v_alignbit_b32 v88, v186, v185, 16
    v_alignbit_b32 v89, v187, v186, 16
    v_alignbit_b32 v90, v188, v187, 16
    v_alignbit_b32 v91, v189, v188, 16
    v_alignbit_b32 v92, v190, v189, 16
    v_alignbit_b32 v93, v191, v190, 16
    v_mov_b32 v94, v185
    v_mov_b32 v95, v186
    v_mov_b32 v96, v187
    v_mov_b32 v97, v188
    v_mov_b32 v98, v189
    v_mov_b32 v99, v190
    v_mov_b32 v100, 0
    v_mov_b32 v101, 0
    v_mov_b32 v102, 0
    v_mov_b32 v103, 0
    v_mov_b32 v13, 148864
    ds_read_b32 v13, v13
    s_waitcnt lgkmcnt(0)
    v_readfirstlane_b32 s68, v13
    s_barrier
    s_branch L_STAGE
L_H_FILT:
    s_and_b32 s89, s69, 1
    s_lshr_b32 s7, s69, 1
    s_mul_i32 s90, s7, 8192
    s_add_u32 s90, s90, 124032
    s_lshl_b32 s88, s2, 1
    s_add_u32 s88, s88, s7
    s_mul_i32 s91, s7, 37440
    s_lshl_b32 s89, s89, 4
    v_lshlrev_b32 v12, 7, v1
    v_lshrrev_b32 v11, 3, v4
    v_sub_u32 v11, v11, v5
    v_and_b32 v16, 7, v4
    v_lshlrev_b32 v16, 6, v16
    s_mul_i32 s7, s89, 576
    s_add_u32 s7, s7, s91
    v_add_u32 v16, s7, v16
    v_add_u32 v13, 3, v11
    v_lshrrev_b32 v17, 2, v13
    v_and_b32 v13, 3, v13
    v_mul_u32_u24 v17, 576, v17
    v_add_u32 v60, v17, v16
    v_lshl_add_u32 v60, v13, 4, v60
    v_add_u32 v13, 1, v11
    v_lshrrev_b32 v17, 2, v13
    v_and_b32 v13, 3, v13
    v_mul_u32_u24 v17, 576, v17
    v_add_u32 v61, v17, v16
    v_lshl_add_u32 v61, v13, 4, v61
    v_mul_u32_u24 v62, 80, v4
    v_lshl_add_u32 v62, v5, 4, v62
    s_mul_i32 s7, s89, 80
    s_sub_u32 s7, s90, s7
    v_add_u32 v62, s7, v62
    s_waitcnt lgkmcnt(0)
    s_branch L_H_FBACK
L_UPREP:
    s_mul_i32 s9, s2, 9363
    s_lshr_b32 s9, s9, 16
    s_mul_i32 s10, s9, 7
    s_sub_u32 s10, s2, s10
    s_and_b32 s7, s69, 1
    s_lshl_b32 s11, s9, 1
    s_add_u32 s11, s11, s7
    s_mul_i32 s12, s11, 28672
    s_lshl_b32 s13, s10, 7
    s_add_u32 s12, s12, s13
    v_and_b32 v10, 15, v1
    v_mul_u32_u24 v8, 7168, v3
    v_lshl_add_u32 v8, v10, 3, v8
    v_add_u32 v8, s12, v8
    v_subrev_u32 v9, 2688, v8
    s_movk_i32 s14, 4480
    s_lshl_b32 s13, s10, 9
    v_lshlrev_b32 v13, 5, v10
    s_waitcnt lgkmcnt(0)
    s_mov_b32 s44, s40
    s_mov_b32 s45, s41
    s_mov_b32 s46, 0xd30000
    s_mov_b32 s47, 0x00020000
    s_mov_b32 s7, 0xca0000
    buffer_load_dword v56, off, s[44:47], s7 sc1
    s_mov_b32 s56, s18
    s_mov_b32 s57, s19
    s_mov_b32 s58, 0x1c0000
    s_mov_b32 s59, 0x00020000
    s_mov_b32 s60, s20
    s_mov_b32 s61, s21
    s_mov_b32 s62, 0x1c0000
    s_mov_b32 s63, 0x00020000
    s_mov_b32 s64, s22
    s_mov_b32 s65, s23
    s_mov_b32 s66, 0xe00
    s_mov_b32 s67, 0x00020000
    buffer_load_dwordx4 v[64:67], v13, s[64:67], s13 offen
    buffer_load_dwordx4 v[68:71], v13, s[64:67], s13 offen offset:16
    buffer_load_dwordx2 v[18:19], v9, s[56:59], 0 offen offset:0 nt
    buffer_load_dwordx2 v[20:21], v9, s[56:59], 0 offen offset:896 nt
    buffer_load_dwordx2 v[22:23], v9, s[56:59], 0 offen offset:1792 nt
    buffer_load_dwordx2 v[24:25], v8, s[56:59], 0 offen offset:0 nt
    buffer_load_dwordx2 v[26:27], v8, s[56:59], 0 offen offset:896 nt
    buffer_load_dwordx2 v[28:29], v8, s[56:59], 0 offen offset:1792 nt
    buffer_load_dwordx2 v[30:31], v8, s[56:59], 0 offen offset:2688 nt
    buffer_load_dwordx2 v[32:33], v8, s[56:59], 0 offen offset:3584 nt
    buffer_load_dwordx2 v[34:35], v8, s[56:59], s14 offen offset:0 nt
    buffer_load_dwordx2 v[36:37], v8, s[56:59], s14 offen offset:896 nt
    buffer_load_dwordx2 v[38:39], v8, s[56:59], s14 offen offset:1792 nt
    buffer_load_dwordx2 v[40:41], v8, s[60:63], 0 offen offset:0 nt
    buffer_load_dwordx2 v[42:43], v8, s[60:63], 0 offen offset:896 nt
    buffer_load_dwordx2 v[44:45], v8, s[60:63], 0 offen offset:1792 nt
    buffer_load_dwordx2 v[46:47], v8, s[60:63], 0 offen offset:2688 nt
    buffer_load_dwordx2 v[48:49], v8, s[60:63], 0 offen offset:3584 nt
    buffer_load_dwordx2 v[50:51], v8, s[60:63], s14 offen offset:0 nt
    buffer_load_dwordx2 v[52:53], v8, s[60:63], s14 offen offset:896 nt
    buffer_load_dwordx2 v[54:55], v8, s[60:63], s14 offen offset:1792 nt
L_UREST:
    s_min_u32 s7, s2, 223
    s_lshl_b32 s7, s7, 2
    s_load_dword s93, s[26:27], s7
    s_and_b32 s89, s69, 1
    s_lshr_b32 s7, s69, 1
    s_mul_i32 s90, s7, 8192
    s_add_u32 s90, s90, 124032
    s_lshl_b32 s88, s2, 1
    s_add_u32 s88, s88, s7
    s_mul_i32 s91, s7, 37440
    s_lshl_b32 s89, s89, 4
    v_lshlrev_b32 v12, 7, v1
    v_lshrrev_b32 v11, 3, v4
    v_sub_u32 v11, v11, v5
    v_and_b32 v16, 7, v4
    v_lshlrev_b32 v16, 6, v16
    s_mul_i32 s7, s89, 576
    s_add_u32 s7, s7, s91
    v_add_u32 v16, s7, v16
    v_add_u32 v13, 3, v11
    v_lshrrev_b32 v17, 2, v13
    v_and_b32 v13, 3, v13
    v_mul_u32_u24 v17, 576, v17
    v_add_u32 v60, v17, v16
    v_lshl_add_u32 v60, v13, 4, v60
    v_add_u32 v13, 1, v11
    v_lshrrev_b32 v17, 2, v13
    v_and_b32 v13, 3, v13
    v_mul_u32_u24 v17, 576, v17
    v_add_u32 v61, v17, v16
    v_lshl_add_u32 v61, v13, 4, v61
    v_mul_u32_u24 v62, 80, v4
    v_lshl_add_u32 v62, v5, 4, v62
    s_mul_i32 s7, s89, 80
    s_sub_u32 s7, s90, s7
    v_add_u32 v62, s7, v62
    s_waitcnt lgkmcnt(0)
    v_lshlrev_b32 v7, 14, v10
    v_lshl_add_u32 v7, v3, 4, v7
    s_lshl_b32 s73, s10, 18
    s_lshl_b32 s13, s11, 6
    s_add_u32 s73, s73, s13
    s_add_u32 s73, s73, 0x600000
    s_lshl_b32 s74, s10, 13
    s_lshl_b32 s8, s11, 7
    s_add_u32 s74, s74, s8
    s_add_u32 s74, s74, 0xcc0000
    s_cmp_ge_u32 s2, 224
    s_cselect_b32 s73, 0x7fff0000, s73
    s_cselect_b32 s74, 0x7fff0000, s74
    s_mov_b32 s15, 0xffff0000
    s_setprio 3
    v_mul_u32_u24 v13, 205, v1
    v_lshrrev_b32 v13, 10, v13
    v_sub_u32 v13, v1, v13
    v_lshlrev_b32 v16, 4, v13
    v_subrev_u32 v16, 1984, v16
    s_and_b32 s77, s69, 1
    s_lshl_b32 s78, s2, 1
    s_add_u32 s78, s78, s77
    s_mul_i32 s77, s77, 8192
    s_add_u32 s77, s77, 124032
    s_lshr_b32 s79, s78, 6
    s_lshl_b32 s79, s79, 13
    s_add_u32 s79, s79, 0xcc0000
    v_add_u32 v166, 0, v16
    v_add_u32 v167, 768, v16
    v_add_u32 v168, 1536, v16
    v_add_u32 v169, 2304, v16
    v_add_u32 v170, 3072, v16
    v_add_u32 v171, 3840, v16
    v_add_u32 v172, 4608, v16
    v_add_u32 v173, 5376, v16
    s_mov_b32 s48, s24
    s_mov_b32 s49, s25
    s_mov_b32 s50, 0x1c0000
    s_mov_b32 s51, 0x00020000
    s_and_b32 s7, s69, 1
    s_mul_i32 s8, s7, 4224
    s_add_u32 s8, s8, 140416
    s_add_u32 m0, s8, 16
    s_lshl_b32 s75, s2, 1
    s_add_u32 s75, s75, s7
    s_lshl_b32 s75, s75, 12
    v_lshl_add_u32 v16, v1, 2, s8
    v_mov_b32 v17, 0
    s_mov_b64 exec, 15
    ds_write_b32 v16, v17
    s_mov_b64 exec, -1
    s_waitcnt vmcnt(19)
    v_lshlrev_b32 v116, 16, v64
    v_and_b32 v120, s15, v64
    v_lshlrev_b32 v124, 16, v65
    v_and_b32 v128, s15, v65
    v_lshlrev_b32 v117, 16, v66
    v_and_b32 v121, s15, v66
    v_lshlrev_b32 v125, 16, v67
    v_and_b32 v129, s15, v67
    v_lshlrev_b32 v118, 16, v68
    v_and_b32 v122, s15, v68
    v_lshlrev_b32 v126, 16, v69
    v_and_b32 v130, s15, v69
    v_lshlrev_b32 v119, 16, v70
    v_and_b32 v123, s15, v70
    v_lshlrev_b32 v127, 16, v71
    v_and_b32 v131, s15, v71
    s_waitcnt vmcnt(15)
    v_lshlrev_b32 v72, 16, v18
    v_and_b32 v73, s15, v18
    v_lshlrev_b32 v74, 16, v19
    v_and_b32 v75, s15, v19
    v_lshlrev_b32 v76, 16, v20
    v_and_b32 v77, s15, v20
    v_lshlrev_b32 v78, 16, v21
    v_and_b32 v79, s15, v21
    v_lshlrev_b32 v80, 16, v22
    v_and_b32 v81, s15, v22
    v_lshlrev_b32 v82, 16, v23
    v_and_b32 v83, s15, v23
    v_lshlrev_b32 v84, 16, v24
    v_and_b32 v85, s15, v24
    v_lshlrev_b32 v86, 16, v25
    v_and_b32 v87, s15, v25
    v_pk_mul_f32 v[132:133], v[84:85], v[116:117]
    v_pk_fma_f32 v[132:133], v[80:81], v[120:121], v[132:133]
    v_pk_fma_f32 v[132:133], v[76:77], v[124:125], v[132:133]
    v_pk_fma_f32 v[132:133], v[72:73], v[128:129], v[132:133]
    v_pk_mul_f32 v[134:135], v[86:87], v[118:119]
    v_pk_fma_f32 v[134:135], v[82:83], v[122:123], v[134:135]
    v_pk_fma_f32 v[134:135], v[78:79], v[126:127], v[134:135]
    v_pk_fma_f32 v[134:135], v[74:75], v[130:131], v[134:135]
    s_waitcnt vmcnt(13)
    v_lshlrev_b32 v88, 16, v26
    v_and_b32 v89, s15, v26
    v_lshlrev_b32 v90, 16, v27
    v_and_b32 v91, s15, v27
    v_pk_mul_f32 v[136:137], v[88:89], v[116:117]
    v_pk_fma_f32 v[136:137], v[84:85], v[120:121], v[136:137]
    v_pk_fma_f32 v[136:137], v[80:81], v[124:125], v[136:137]
    v_pk_fma_f32 v[136:137], v[76:77], v[128:129], v[136:137]
    v_pk_mul_f32 v[138:139], v[90:91], v[118:119]
    v_pk_fma_f32 v[138:139], v[86:87], v[122:123], v[138:139]
    v_pk_fma_f32 v[138:139], v[82:83], v[126:127], v[138:139]
    v_pk_fma_f32 v[138:139], v[78:79], v[130:131], v[138:139]
    v_lshlrev_b32 v92, 16, v28
    v_and_b32 v93, s15, v28
    v_lshlrev_b32 v94, 16, v29
    v_and_b32 v95, s15, v29
    v_pk_mul_f32 v[140:141], v[92:93], v[116:117]
    v_pk_fma_f32 v[140:141], v[88:89], v[120:121], v[140:141]
    v_pk_fma_f32 v[140:141], v[84:85], v[124:125], v[140:141]
    v_pk_fma_f32 v[140:141], v[80:81], v[128:129], v[140:141]
    v_pk_mul_f32 v[142:143], v[94:95], v[118:119]
    v_pk_fma_f32 v[142:143], v[90:91], v[122:123], v[142:143]
    v_pk_fma_f32 v[142:143], v[86:87], v[126:127], v[142:143]
    v_pk_fma_f32 v[142:143], v[82:83], v[130:131], v[142:143]
    s_waitcnt vmcnt(11)
    v_lshlrev_b32 v96, 16, v30
    v_and_b32 v97, s15, v30
    v_lshlrev_b32 v98, 16, v31
    v_and_b32 v99, s15, v31
    v_pk_mul_f32 v[144:145], v[96:97], v[116:117]
    v_pk_fma_f32 v[144:145], v[92:93], v[120:121], v[144:145]
    v_pk_fma_f32 v[144:145], v[88:89], v[124:125], v[144:145]
    v_pk_fma_f32 v[144:145], v[84:85], v[128:129], v[144:145]
    v_pk_mul_f32 v[146:147], v[98:99], v[118:119]
    v_pk_fma_f32 v[146:147], v[94:95], v[122:123], v[146:147]
    v_pk_fma_f32 v[146:147], v[90:91], v[126:127], v[146:147]
    v_pk_fma_f32 v[146:147], v[86:87], v[130:131], v[146:147]
    v_lshlrev_b32 v100, 16, v32
    v_and_b32 v101, s15, v32
    v_lshlrev_b32 v102, 16, v33
    v_and_b32 v103, s15, v33
    v_pk_mul_f32 v[148:149], v[100:101], v[116:117]
    v_pk_fma_f32 v[148:149], v[96:97], v[120:121], v[148:149]
    v_pk_fma_f32 v[148:149], v[92:93], v[124:125], v[148:149]
    v_pk_fma_f32 v[148:149], v[88:89], v[128:129], v[148:149]
    v_pk_mul_f32 v[150:151], v[102:103], v[118:119]
    v_pk_fma_f32 v[150:151], v[98:99], v[122:123], v[150:151]
    v_pk_fma_f32 v[150:151], v[94:95], v[126:127], v[150:151]
    v_pk_fma_f32 v[150:151], v[90:91], v[130:131], v[150:151]
    s_waitcnt vmcnt(9)
    v_lshlrev_b32 v104, 16, v34
    v_and_b32 v105, s15, v34
    v_lshlrev_b32 v106, 16, v35
    v_and_b32 v107, s15, v35
    v_pk_mul_f32 v[152:153], v[104:105], v[116:117]
    v_pk_fma_f32 v[152:153], v[100:101], v[120:121], v[152:153]
    v_pk_fma_f32 v[152:153], v[96:97], v[124:125], v[152:153]
    v_pk_fma_f32 v[152:153], v[92:93], v[128:129], v[152:153]
    v_pk_mul_f32 v[154:155], v[106:107], v[118:119]
    v_pk_fma_f32 v[154:155], v[102:103], v[122:123], v[154:155]
    v_pk_fma_f32 v[154:155], v[98:99], v[126:127], v[154:155]
    v_pk_fma_f32 v[154:155], v[94:95], v[130:131], v[154:155]
    v_lshlrev_b32 v108, 16, v36
    v_and_b32 v109, s15, v36
    v_lshlrev_b32 v110, 16, v37
    v_and_b32 v111, s15, v37
    v_pk_mul_f32 v[156:157], v[108:109], v[116:117]
    v_pk_fma_f32 v[156:157], v[104:105], v[120:121], v[156:157]
    v_pk_fma_f32 v[156:157], v[100:101], v[124:125], v[156:157]
    v_pk_fma_f32 v[156:157], v[96:97], v[128:129], v[156:157]
    v_pk_mul_f32 v[158:159], v[110:111], v[118:119]
    v_pk_fma_f32 v[158:159], v[106:107], v[122:123], v[158:159]
    v_pk_fma_f32 v[158:159], v[102:103], v[126:127], v[158:159]
    v_pk_fma_f32 v[158:159], v[98:99], v[130:131], v[158:159]
    s_waitcnt vmcnt(8)
    v_lshlrev_b32 v112, 16, v38
    v_and_b32 v113, s15, v38
    v_lshlrev_b32 v114, 16, v39
    v_and_b32 v115, s15, v39
    v_pk_mul_f32 v[160:161], v[112:113], v[116:117]
    v_pk_fma_f32 v[160:161], v[108:109], v[120:121], v[160:161]
    v_pk_fma_f32 v[160:161], v[104:105], v[124:125], v[160:161]
    v_pk_fma_f32 v[160:161], v[100:101], v[128:129], v[160:161]
    v_pk_mul_f32 v[162:163], v[114:115], v[118:119]
    v_pk_fma_f32 v[162:163], v[110:111], v[122:123], v[162:163]
    v_pk_fma_f32 v[162:163], v[106:107], v[126:127], v[162:163]
    v_pk_fma_f32 v[162:163], v[102:103], v[130:131], v[162:163]
    s_waitcnt vmcnt(6)
    v_lshlrev_b32 v164, 16, v40
    v_and_b32 v165, s15, v40
    v_pk_mul_f32 v[132:133], v[132:133], v[164:165]
    v_lshlrev_b32 v164, 16, v41
    v_and_b32 v165, s15, v41
    v_pk_mul_f32 v[134:135], v[134:135], v[164:165]
    v_lshlrev_b32 v164, 16, v42
    v_and_b32 v165, s15, v42
    v_pk_mul_f32 v[136:137], v[136:137], v[164:165]
    v_lshlrev_b32 v164, 16, v43
    v_and_b32 v165, s15, v43
    v_pk_mul_f32 v[138:139], v[138:139], v[164:165]
    v_cvt_pk_bf16_f32 v21, v136, v132
    v_cvt_pk_bf16_f32 v25, v137, v133
    v_cvt_pk_bf16_f32 v29, v138, v134
    v_cvt_pk_bf16_f32 v33, v139, v135
    s_waitcnt vmcnt(4)
    v_lshlrev_b32 v164, 16, v44
    v_and_b32 v165, s15, v44
    v_pk_mul_f32 v[140:141], v[140:141], v[164:165]
    v_lshlrev_b32 v164, 16, v45
    v_and_b32 v165, s15, v45
    v_pk_mul_f32 v[142:143], v[142:143], v[164:165]
    v_lshlrev_b32 v164, 16, v46
    v_and_b32 v165, s15, v46
    v_pk_mul_f32 v[144:145], v[144:145], v[164:165]
    v_lshlrev_b32 v164, 16, v47
    v_and_b32 v165, s15, v47
    v_pk_mul_f32 v[146:147], v[146:147], v[164:165]
    v_cvt_pk_bf16_f32 v20, v144, v140
    v_cvt_pk_bf16_f32 v24, v145, v141
    v_cvt_pk_bf16_f32 v28, v146, v142
    v_cvt_pk_bf16_f32 v32, v147, v143
    s_waitcnt vmcnt(2)
    v_lshlrev_b32 v164, 16, v48
    v_and_b32 v165, s15, v48
    v_pk_mul_f32 v[148:149], v[148:149], v[164:165]
    v_lshlrev_b32 v164, 16, v49
    v_and_b32 v165, s15, v49
    v_pk_mul_f32 v[150:151], v[150:151], v[164:165]
    v_lshlrev_b32 v164, 16, v50
    v_and_b32 v165, s15, v50
    v_pk_mul_f32 v[152:153], v[152:153], v[164:165]
    v_lshlrev_b32 v164, 16, v51
    v_and_b32 v165, s15, v51
    v_pk_mul_f32 v[154:155], v[154:155], v[164:165]
    v_cvt_pk_bf16_f32 v19, v152, v148
    v_cvt_pk_bf16_f32 v23, v153, v149
    v_cvt_pk_bf16_f32 v27, v154, v150
    v_cvt_pk_bf16_f32 v31, v155, v151
    s_waitcnt vmcnt(0)
    v_lshlrev_b32 v164, 16, v52
    v_and_b32 v165, s15, v52
    v_pk_mul_f32 v[156:157], v[156:157], v[164:165]
    v_lshlrev_b32 v164, 16, v53
    v_and_b32 v165, s15, v53
    v_pk_mul_f32 v[158:159], v[158:159], v[164:165]
    v_lshlrev_b32 v164, 16, v54
    v_and_b32 v165, s15, v54
    v_pk_mul_f32 v[160:161], v[160:161], v[164:165]
    v_lshlrev_b32 v164, 16, v55
    v_and_b32 v165, s15, v55
    v_pk_mul_f32 v[162:163], v[162:163], v[164:165]
    v_cvt_pk_bf16_f32 v18, v160, v156
    v_cvt_pk_bf16_f32 v22, v161, v157
    v_cvt_pk_bf16_f32 v26, v162, v158
    v_cvt_pk_bf16_f32 v30, v163, v159
    buffer_store_dwordx4 v[18:21], v7, s[44:47], s73 offen sc1
    s_add_u32 s73, s73, 4096
    buffer_store_dwordx4 v[22:25], v7, s[44:47], s73 offen sc1
    s_add_u32 s73, s73, 4096
    buffer_store_dwordx4 v[26:29], v7, s[44:47], s73 offen sc1
    s_add_u32 s73, s73, 4096
    buffer_store_dwordx4 v[30:33], v7, s[44:47], s73 offen sc1
    buffer_load_dwordx4 v2, s[48:51], s75 offen offset:0 nt lds
    buffer_load_dwordx4 v2, s[48:51], s75 offen offset:1024 nt lds
    buffer_load_dwordx4 v2, s[48:51], s75 offen offset:2048 nt lds
    buffer_load_dwordx4 v2, s[48:51], s75 offen offset:3072 nt lds
    s_barrier
    s_mov_b32 s7, 0x9e3779b1
    v_mul_lo_u32 v56, v56, s7
    v_add_u32 v56, 0x7f4a7c15, v56
    v_mov_b32 v11, 148864
    v_readfirstlane_b32 s68, v56
    v_mov_b32 v57, v56
    v_mov_b32 v58, v56
    v_mov_b32 v59, v56
    s_mov_b64 exec, 1
    ds_write_b32 v11, v56
    s_mov_b64 exec, -1
    s_waitcnt lgkmcnt(0)
    s_barrier
    s_barrier
    s_waitcnt vmcnt(0) lgkmcnt(0)
    s_mov_b64 exec, 0xff
    buffer_store_dwordx4 v[56:59], v2, s[44:47], s74 offen sc1
    s_mov_b64 exec, -1
    s_mov_b32 s60, s40
    s_mov_b32 s61, s41
    s_mov_b32 s62, 0x1000
    s_mov_b32 s63, 0x00020000
    s_lshl_b32 s7, s78, 12
    s_add_u32 s7, s7, 0x600000
    s_add_u32 s60, s60, s7
    s_addc_u32 s61, s61, 0
    s_barrier
    s_lshr_b32 s7, s69, 1
    s_mul_i32 s8, s7, 4224
    s_lshl_b32 s9, s89, 7
    s_add_u32 s8, s8, s9
    s_add_u32 s8, s8, 140416
    v_add_u32 v174, s8, v2
    ds_read_b128 v[176:179], v174
    ds_read_b128 v[180:183], v174 offset:16
    ds_read_b128 v[184:187], v174 offset:1024
    ds_read_b128 v[188:191], v174 offset:1040
    s_lshl_b32 s7, s7, 4
    s_lshr_b32 s7, s93, s7
    s_lshl_b32 s7, s7, 16
    v_add_u32 v175, s89, v1
    s_waitcnt lgkmcnt(0)
    v_lshlrev_b32 v16, 16, v180
    v_add_f32 v16, s7, v16
    v_and_b32 v17, 0xffff0000, v180
    v_cvt_pk_bf16_f32 v16, v16, v17
    v_cmp_eq_u32 vcc, 0, v175
    s_lshl_b32 s7, s89, 3
    v_add_u32 v17, 3, v1
    v_cndmask_b32 v180, v180, v16, vcc
    v_add_u32 v17, s7, v17
    v_lshrrev_b32 v174, 2, v17
    v_and_b32 v17, 3, v17
    v_mul_u32_u24 v174, 576, v174
    v_lshl_add_u32 v174, v17, 4, v174
    v_add_u32 v174, s91, v174
    v_add_u32 v175, s91, v2
    v_alignbit_b32 v64, v177, v176, 16
    v_alignbit_b32 v65, v178, v177, 16
    v_alignbit_b32 v66, v179, v178, 16
    v_alignbit_b32 v67, v180, v179, 16
    v_alignbit_b32 v68, v181, v180, 16
    v_alignbit_b32 v69, v182, v181, 16
    v_alignbit_b32 v70, v178, v177, 16
    v_alignbit_b32 v71, v179, v178, 16
    v_alignbit_b32 v72, v180, v179, 16
    v_alignbit_b32 v73, v181, v180, 16
    v_alignbit_b32 v74, v182, v181, 16
    v_alignbit_b32 v75, v183, v182, 16
    v_mov_b32 v76, v177
    v_mov_b32 v77, v178
    v_mov_b32 v78, v179
    v_mov_b32 v79, v180
    v_mov_b32 v80, v181
    v_mov_b32 v81, v182
    v_alignbit_b32 v82, v185, v184, 16
    v_alignbit_b32 v83, v186, v185, 16
    v_alignbit_b32 v84, v187, v186, 16
    v_alignbit_b32 v85, v188, v187, 16
    v_alignbit_b32 v86, v189, v188, 16
    v_alignbit_b32 v87, v190, v189, 16
    v_alignbit_b32 v88, v186, v185, 16
    v_alignbit_b32 v89, v187, v186, 16
    v_alignbit_b32 v90, v188, v187, 16
    v_alignbit_b32 v91, v189, v188, 16
    v_alignbit_b32 v92, v190, v189, 16
    v_alignbit_b32 v93, v191, v190, 16
    v_mov_b32 v94, v185
    v_mov_b32 v95, v186
    v_mov_b32 v96, v187
    v_mov_b32 v97, v188
    v_mov_b32 v98, v189
    v_mov_b32 v99, v190
    v_mov_b32 v100, 0
    v_mov_b32 v101, 0
    v_mov_b32 v102, 0
    v_mov_b32 v103, 0
    s_barrier
    s_barrier
    buffer_load_dword v63, v12, s[44:47], s79 offen sc1
    s_barrier
    s_waitcnt vmcnt(0)
    s_mov_b32 s76, 0
    v_cmp_ne_u32 vcc, s68, v63
    s_cbranch_vccnz L_G_LATE
    s_mov_b32 s76, 1
    s_mov_b32 exec_lo, 0xdef7bdef
    s_mov_b32 exec_hi, 0x7bdef7b
    s_add_u32 m0, s77, 0
    s_nop 0
    buffer_load_dwordx4 v166, s[60:63], 0 offen sc1 lds
    s_add_u32 m0, s77, 960
    s_nop 0
    buffer_load_dwordx4 v167, s[60:63], 0 offen sc1 lds
    s_add_u32 m0, s77, 1920
    s_nop 0
    buffer_load_dwordx4 v168, s[60:63], 0 offen sc1 lds
    s_add_u32 m0, s77, 2880
    s_nop 0
    buffer_load_dwordx4 v169, s[60:63], 0 offen sc1 lds
    s_add_u32 m0, s77, 3840
    s_nop 0
    buffer_load_dwordx4 v170, s[60:63], 0 offen sc1 lds
    s_add_u32 m0, s77, 4800
    s_nop 0
    buffer_load_dwordx4 v171, s[60:63], 0 offen sc1 lds
    s_add_u32 m0, s77, 5760
    s_nop 0
    buffer_load_dwordx4 v172, s[60:63], 0 offen sc1 lds
    s_add_u32 m0, s77, 6720
    s_nop 0
    buffer_load_dwordx4 v173, s[60:63], 0 offen sc1 lds
    s_mov_b64 exec, -1
L_G_LATE:
    s_barrier
    s_cmp_ge_u32 s2, 224
    s_cbranch_scc1 L_STAGE
    s_cmp_eq_u32 s76, 1
    s_cbranch_scc1 L_STAGE
    s_mov_b32 s98, 131072
    s_mov_b64 exec, -1
POLL_1:
    buffer_load_dword v13, v12, s[44:47], s79 offen sc1
    s_waitcnt vmcnt(0)
    v_cmp_ne_u32 vcc, s68, v13
    s_cbranch_vccnz RETRY_2
    s_mov_b64 exec, -1
    s_mov_b32 exec_lo, 0xdef7bdef
    s_mov_b32 exec_hi, 0x7bdef7b
    s_add_u32 m0, s77, 0
    s_nop 0
    buffer_load_dwordx4 v166, s[60:63], 0 offen sc1 lds
    s_add_u32 m0, s77, 960
    s_nop 0
    buffer_load_dwordx4 v167, s[60:63], 0 offen sc1 lds
    s_add_u32 m0, s77, 1920
    s_nop 0
    buffer_load_dwordx4 v168, s[60:63], 0 offen sc1 lds
    s_add_u32 m0, s77, 2880
    s_nop 0
    buffer_load_dwordx4 v169, s[60:63], 0 offen sc1 lds
    s_add_u32 m0, s77, 3840
    s_nop 0
    buffer_load_dwordx4 v170, s[60:63], 0 offen sc1 lds
    s_add_u32 m0, s77, 4800
    s_nop 0
    buffer_load_dwordx4 v171, s[60:63], 0 offen sc1 lds
    s_add_u32 m0, s77, 5760
    s_nop 0
    buffer_load_dwordx4 v172, s[60:63], 0 offen sc1 lds
    s_add_u32 m0, s77, 6720
    s_nop 0
    buffer_load_dwordx4 v173, s[60:63], 0 offen sc1 lds
    s_mov_b64 exec, -1
L_STAGE:
    s_setprio 0
    s_mov_b32 s77, 0x7fff0000
    s_cmp_ge_u32 s2, 224
    s_cbranch_scc1 L_WOPREP
    ds_write_b128 v174, v[64:67] offset:0
    ds_write_b128 v174, v[76:79] offset:64
    ds_write_b128 v174, v[70:73] offset:128
    ds_write_b128 v174, v[178:181] offset:192
    ds_write_b128 v174, v[66:69] offset:256
    ds_write_b128 v174, v[78:81] offset:320
    ds_write_b128 v174, v[72:75] offset:384
    ds_write_b128 v174, v[180:183] offset:448
    ds_write_b128 v174, v[82:85] offset:9216
    ds_write_b128 v174, v[94:97] offset:9280
    ds_write_b128 v174, v[88:91] offset:9344
    ds_write_b128 v174, v[186:189] offset:9408
    ds_write_b128 v174, v[84:87] offset:9472
    ds_write_b128 v174, v[96:99] offset:9536
    ds_write_b128 v174, v[90:93] offset:9600
    ds_write_b128 v174, v[188:191] offset:9664
    s_mov_b32 exec_lo, 0x77777777
    s_mov_b32 exec_hi, 0
    ds_write_b128 v175, v[100:103]
    s_mov_b64 exec, -1
    s_mov_b32 s7, 0
    s_waitcnt vmcnt(0)
    s_add_u32 s7, s7, 148896
    v_mov_b32 v10, s7
    v_mov_b32 v11, 1
    s_waitcnt lgkmcnt(0)
    s_mov_b64 exec, 1
    ds_add_u32 v10, v11
    s_mov_b64 exec, -1
    s_mov_b32 s98, 2097152
LSPIN_3:
    ds_read_b32 v14, v10 offset:0
    s_waitcnt lgkmcnt(0)
    v_cmp_le_u16 vcc, 4, v14
    s_cbranch_vccz RETRY_4
    ds_read_b128 v[24:27], v62 offset:5040
    ds_read_b128 v[16:19], v60 offset:0
    ds_read_b128 v[28:31], v62 offset:2480
    ds_read_b128 v[20:23], v60 offset:18432
    ds_read_b128 v[40:43], v62 offset:5072
    ds_read_b128 v[32:35], v61 offset:0
    ds_read_b128 v[44:47], v62 offset:2512
    ds_read_b128 v[36:39], v61 offset:18432
    s_waitcnt lgkmcnt(6)
    v_mfma_f32_32x32x16_bf16 a[16:31], v[16:19], v[24:27], 0
    ds_read_b128 v[24:27], v62 offset:4960
    s_waitcnt lgkmcnt(6)
    v_mfma_f32_32x32x16_bf16 a[0:15], v[16:19], v[28:31], 0
    ds_read_b128 v[16:19], v60 offset:576
    s_waitcnt lgkmcnt(6)
    v_mfma_f32_32x32x16_bf16 a[16:31], v[20:23], v[28:31], a[16:31]
    ds_read_b128 v[28:31], v62 offset:2400
    ds_read_b128 v[20:23], v60 offset:19008
    s_waitcnt lgkmcnt(6)
    v_mfma_f32_32x32x16_bf16 a[16:31], v[32:35], v[40:43], a[16:31]
    ds_read_b128 v[40:43], v62 offset:4992
    s_waitcnt lgkmcnt(6)
    v_mfma_f32_32x32x16_bf16 a[0:15], v[32:35], v[44:47], a[0:15]
    ds_read_b128 v[32:35], v61 offset:576
    s_waitcnt lgkmcnt(6)
    v_mfma_f32_32x32x16_bf16 a[16:31], v[36:39], v[44:47], a[16:31]
    ds_read_b128 v[44:47], v62 offset:2432
    ds_read_b128 v[36:39], v61 offset:19008
    s_waitcnt lgkmcnt(6)
    v_mfma_f32_32x32x16_bf16 a[16:31], v[16:19], v[24:27], a[16:31]
    ds_read_b128 v[24:27], v62 offset:4880
    s_waitcnt lgkmcnt(6)
    v_mfma_f32_32x32x16_bf16 a[0:15], v[16:19], v[28:31], a[0:15]
    ds_read_b128 v[16:19], v60 offset:1152
    s_waitcnt lgkmcnt(6)
    v_mfma_f32_32x32x16_bf16 a[16:31], v[20:23], v[28:31], a[16:31]
    ds_read_b128 v[28:31], v62 offset:2320
    ds_read_b128 v[20:23], v60 offset:19584
    s_waitcnt lgkmcnt(6)
    v_mfma_f32_32x32x16_bf16 a[16:31], v[32:35], v[40:43], a[16:31]
    ds_read_b128 v[40:43], v62 offset:4912
    s_waitcnt lgkmcnt(6)
    v_mfma_f32_32x32x16_bf16 a[0:15], v[32:35], v[44:47], a[0:15]
    ds_read_b128 v[32:35], v61 offset:1152
    s_waitcnt lgkmcnt(6)
    v_mfma_f32_32x32x16_bf16 a[16:31], v[36:39], v[44:47], a[16:31]
    ds_read_b128 v[44:47], v62 offset:2352
    ds_read_b128 v[36:39], v61 offset:19584
    s_waitcnt lgkmcnt(6)
    v_mfma_f32_32x32x16_bf16 a[16:31], v[16:19], v[24:27], a[16:31]
    ds_read_b128 v[24:27], v62 offset:4800
    s_waitcnt lgkmcnt(6)
    v_mfma_f32_32x32x16_bf16 a[0:15], v[16:19], v[28:31], a[0:15]
    ds_read_b128 v[16:19], v60 offset:1728
    s_waitcnt lgkmcnt(6)
    v_mfma_f32_32x32x16_bf16 a[16:31], v[20:23], v[28:31], a[16:31]
    ds_read_b128 v[28:31], v62 offset:2240
    ds_read_b128 v[20:23], v60 offset:20160
    s_waitcnt lgkmcnt(6)
    v_mfma_f32_32x32x16_bf16 a[16:31], v[32:35], v[40:43], a[16:31]
    ds_read_b128 v[40:43], v62 offset:4832
    s_waitcnt lgkmcnt(6)
    v_mfma_f32_32x32x16_bf16 a[0:15], v[32:35], v[44:47], a[0:15]
    ds_read_b128 v[32:35], v61 offset:1728
    s_waitcnt lgkmcnt(6)
    v_mfma_f32_32x32x16_bf16 a[16:31], v[36:39], v[44:47], a[16:31]
    ds_read_b128 v[44:47], v62 offset:2272
    ds_read_b128 v[36:39], v61 offset:20160
    s_waitcnt lgkmcnt(6)
    v_mfma_f32_32x32x16_bf16 a[16:31], v[16:19], v[24:27], a[16:31]
    ds_read_b128 v[24:27], v62 offset:4720
    s_waitcnt lgkmcnt(6)
    v_mfma_f32_32x32x16_bf16 a[0:15], v[16:19], v[28:31], a[0:15]
    ds_read_b128 v[16:19], v60 offset:2304
    s_waitcnt lgkmcnt(6)
    v_mfma_f32_32x32x16_bf16 a[16:31], v[20:23], v[28:31], a[16:31]
    ds_read_b128 v[28:31], v62 offset:2160
    ds_read_b128 v[20:23], v60 offset:20736
    s_waitcnt lgkmcnt(6)
    v_mfma_f32_32x32x16_bf16 a[16:31], v[32:35], v[40:43], a[16:31]
    ds_read_b128 v[40:43], v62 offset:4752
    s_waitcnt lgkmcnt(6)
    v_mfma_f32_32x32x16_bf16 a[0:15], v[32:35], v[44:47], a[0:15]
    ds_read_b128 v[32:35], v61 offset:2304
    s_waitcnt lgkmcnt(6)
    v_mfma_f32_32x32x16_bf16 a[16:31], v[36:39], v[44:47], a[16:31]
    ds_read_b128 v[44:47], v62 offset:2192
    ds_read_b128 v[36:39], v61 offset:20736
    s_waitcnt lgkmcnt(6)
    v_mfma_f32_32x32x16_bf16 a[16:31], v[16:19], v[24:27], a[16:31]
    ds_read_b128 v[24:27], v62 offset:4640
    s_waitcnt lgkmcnt(6)
    v_mfma_f32_32x32x16_bf16 a[0:15], v[16:19], v[28:31], a[0:15]
    ds_read_b128 v[16:19], v60 offset:2880
    s_waitcnt lgkmcnt(6)
    v_mfma_f32_32x32x16_bf16 a[16:31], v[20:23], v[28:31], a[16:31]
    ds_read_b128 v[28:31], v62 offset:2080
    ds_read_b128 v[20:23], v60 offset:21312
    s_waitcnt lgkmcnt(6)
    v_mfma_f32_32x32x16_bf16 a[16:31], v[32:35], v[40:43], a[16:31]
    ds_read_b128 v[40:43], v62 offset:4672
    s_waitcnt lgkmcnt(6)
    v_mfma_f32_32x32x16_bf16 a[0:15], v[32:35], v[44:47], a[0:15]
    ds_read_b128 v[32:35], v61 offset:2880
    s_waitcnt lgkmcnt(6)
    v_mfma_f32_32x32x16_bf16 a[16:31], v[36:39], v[44:47], a[16:31]
    ds_read_b128 v[44:47], v62 offset:2112
    ds_read_b128 v[36:39], v61 offset:21312
    s_waitcnt lgkmcnt(6)
    v_mfma_f32_32x32x16_bf16 a[16:31], v[16:19], v[24:27], a[16:31]
    ds_read_b128 v[24:27], v62 offset:4560
    s_waitcnt lgkmcnt(6)
    v_mfma_f32_32x32x16_bf16 a[0:15], v[16:19], v[28:31], a[0:15]
    ds_read_b128 v[16:19], v60 offset:3456
    s_waitcnt lgkmcnt(6)
    v_mfma_f32_32x32x16_bf16 a[16:31], v[20:23], v[28:31], a[16:31]
    ds_read_b128 v[28:31], v62 offset:2000
    ds_read_b128 v[20:23], v60 offset:21888
    s_waitcnt lgkmcnt(6)
    v_mfma_f32_32x32x16_bf16 a[16:31], v[32:35], v[40:43], a[16:31]
    ds_read_b128 v[40:43], v62 offset:4592
    s_waitcnt lgkmcnt(6)
    v_mfma_f32_32x32x16_bf16 a[0:15], v[32:35], v[44:47], a[0:15]
    ds_read_b128 v[32:35], v61 offset:3456
    s_waitcnt lgkmcnt(6)
    v_mfma_f32_32x32x16_bf16 a[16:31], v[36:39], v[44:47], a[16:31]
    ds_read_b128 v[44:47], v62 offset:2032
    ds_read_b128 v[36:39], v61 offset:21888
    s_waitcnt lgkmcnt(6)
    v_mfma_f32_32x32x16_bf16 a[16:31], v[16:19], v[24:27], a[16:31]
    ds_read_b128 v[24:27], v62 offset:4480
    s_waitcnt lgkmcnt(6)
    v_mfma_f32_32x32x16_bf16 a[0:15], v[16:19], v[28:31], a[0:15]
    ds_read_b128 v[16:19], v60 offset:4032
    s_waitcnt lgkmcnt(6)
    v_mfma_f32_32x32x16_bf16 a[16:31], v[20:23], v[28:31], a[16:31]
    ds_read_b128 v[28:31], v62 offset:1920
    ds_read_b128 v[20:23], v60 offset:22464
    s_waitcnt lgkmcnt(6)
    v_mfma_f32_32x32x16_bf16 a[16:31], v[32:35], v[40:43], a[16:31]
    ds_read_b128 v[40:43], v62 offset:4512
    s_waitcnt lgkmcnt(6)
    v_mfma_f32_32x32x16_bf16 a[0:15], v[32:35], v[44:47], a[0:15]
    ds_read_b128 v[32:35], v61 offset:4032
    s_waitcnt lgkmcnt(6)
    v_mfma_f32_32x32x16_bf16 a[16:31], v[36:39], v[44:47], a[16:31]
    ds_read_b128 v[44:47], v62 offset:1952
    ds_read_b128 v[36:39], v61 offset:22464
    s_waitcnt lgkmcnt(6)
    v_mfma_f32_32x32x16_bf16 a[16:31], v[16:19], v[24:27], a[16:31]
    ds_read_b128 v[24:27], v62 offset:4400
    s_waitcnt lgkmcnt(6)
    v_mfma_f32_32x32x16_bf16 a[0:15], v[16:19], v[28:31], a[0:15]
    ds_read_b128 v[16:19], v60 offset:4608
    s_waitcnt lgkmcnt(6)
    v_mfma_f32_32x32x16_bf16 a[16:31], v[20:23], v[28:31], a[16:31]
    ds_read_b128 v[28:31], v62 offset:1840
    ds_read_b128 v[20:23], v60 offset:23040
    s_waitcnt lgkmcnt(6)
    v_mfma_f32_32x32x16_bf16 a[16:31], v[32:35], v[40:43], a[16:31]
    ds_read_b128 v[40:43], v62 offset:4432
    s_waitcnt lgkmcnt(6)
    v_mfma_f32_32x32x16_bf16 a[0:15], v[32:35], v[44:47], a[0:15]
    ds_read_b128 v[32:35], v61 offset:4608
    s_waitcnt lgkmcnt(6)
    v_mfma_f32_32x32x16_bf16 a[16:31], v[36:39], v[44:47], a[16:31]
    ds_read_b128 v[44:47], v62 offset:1872
    ds_read_b128 v[36:39], v61 offset:23040
    s_waitcnt lgkmcnt(6)
    v_mfma_f32_32x32x16_bf16 a[16:31], v[16:19], v[24:27], a[16:31]
    ds_read_b128 v[24:27], v62 offset:4320
    s_waitcnt lgkmcnt(6)
    v_mfma_f32_32x32x16_bf16 a[0:15], v[16:19], v[28:31], a[0:15]
    ds_read_b128 v[16:19], v60 offset:5184
    s_waitcnt lgkmcnt(6)
    v_mfma_f32_32x32x16_bf16 a[16:31], v[20:23], v[28:31], a[16:31]
    ds_read_b128 v[28:31], v62 offset:1760
    ds_read_b128 v[20:23], v60 offset:23616
    s_waitcnt lgkmcnt(6)
    v_mfma_f32_32x32x16_bf16 a[16:31], v[32:35], v[40:43], a[16:31]
    ds_read_b128 v[40:43], v62 offset:4352
    s_waitcnt lgkmcnt(6)
    v_mfma_f32_32x32x16_bf16 a[0:15], v[32:35], v[44:47], a[0:15]
    ds_read_b128 v[32:35], v61 offset:5184
    s_waitcnt lgkmcnt(6)
    v_mfma_f32_32x32x16_bf16 a[16:31], v[36:39], v[44:47], a[16:31]
    ds_read_b128 v[44:47], v62 offset:1792
    ds_read_b128 v[36:39], v61 offset:23616
    s_waitcnt lgkmcnt(6)
    v_mfma_f32_32x32x16_bf16 a[16:31], v[16:19], v[24:27], a[16:31]
    ds_read_b128 v[24:27], v62 offset:4240
    s_waitcnt lgkmcnt(6)
    v_mfma_f32_32x32x16_bf16 a[0:15], v[16:19], v[28:31], a[0:15]
    ds_read_b128 v[16:19], v60 offset:5760
    s_waitcnt lgkmcnt(6)
    v_mfma_f32_32x32x16_bf16 a[16:31], v[20:23], v[28:31], a[16:31]
    ds_read_b128 v[28:31], v62 offset:1680
    ds_read_b128 v[20:23], v60 offset:24192
    s_waitcnt lgkmcnt(6)
    v_mfma_f32_32x32x16_bf16 a[16:31], v[32:35], v[40:43], a[16:31]
    ds_read_b128 v[40:43], v62 offset:4272
    s_waitcnt lgkmcnt(6)
    v_mfma_f32_32x32x16_bf16 a[0:15], v[32:35], v[44:47], a[0:15]
    ds_read_b128 v[32:35], v61 offset:5760
    s_waitcnt lgkmcnt(6)
    v_mfma_f32_32x32x16_bf16 a[16:31], v[36:39], v[44:47], a[16:31]
    ds_read_b128 v[44:47], v62 offset:1712
    ds_read_b128 v[36:39], v61 offset:24192
    s_waitcnt lgkmcnt(6)
    v_mfma_f32_32x32x16_bf16 a[16:31], v[16:19], v[24:27], a[16:31]
    ds_read_b128 v[24:27], v62 offset:4160
    s_waitcnt lgkmcnt(6)
    v_mfma_f32_32x32x16_bf16 a[0:15], v[16:19], v[28:31], a[0:15]
    ds_read_b128 v[16:19], v60 offset:6336
    s_waitcnt lgkmcnt(6)
    v_mfma_f32_32x32x16_bf16 a[16:31], v[20:23], v[28:31], a[16:31]
    ds_read_b128 v[28:31], v62 offset:1600
    ds_read_b128 v[20:23], v60 offset:24768
    s_waitcnt lgkmcnt(6)
    v_mfma_f32_32x32x16_bf16 a[16:31], v[32:35], v[40:43], a[16:31]
    ds_read_b128 v[40:43], v62 offset:4192
    s_waitcnt lgkmcnt(6)
    v_mfma_f32_32x32x16_bf16 a[0:15], v[32:35], v[44:47], a[0:15]
    ds_read_b128 v[32:35], v61 offset:6336
    s_waitcnt lgkmcnt(6)
    v_mfma_f32_32x32x16_bf16 a[16:31], v[36:39], v[44:47], a[16:31]
    ds_read_b128 v[44:47], v62 offset:1632
    ds_read_b128 v[36:39], v61 offset:24768
    s_waitcnt lgkmcnt(6)
    v_mfma_f32_32x32x16_bf16 a[16:31], v[16:19], v[24:27], a[16:31]
    ds_read_b128 v[24:27], v62 offset:4080
    s_waitcnt lgkmcnt(6)
    v_mfma_f32_32x32x16_bf16 a[0:15], v[16:19], v[28:31], a[0:15]
    ds_read_b128 v[16:19], v60 offset:6912
    s_waitcnt lgkmcnt(6)
    v_mfma_f32_32x32x16_bf16 a[16:31], v[20:23], v[28:31], a[16:31]
    ds_read_b128 v[28:31], v62 offset:1520
    ds_read_b128 v[20:23], v60 offset:25344
    s_waitcnt lgkmcnt(6)
    v_mfma_f32_32x32x16_bf16 a[16:31], v[32:35], v[40:43], a[16:31]
    ds_read_b128 v[40:43], v62 offset:4112
    s_waitcnt lgkmcnt(6)
    v_mfma_f32_32x32x16_bf16 a[0:15], v[32:35], v[44:47], a[0:15]
    ds_read_b128 v[32:35], v61 offset:6912
    s_waitcnt lgkmcnt(6)
    v_mfma_f32_32x32x16_bf16 a[16:31], v[36:39], v[44:47], a[16:31]
    ds_read_b128 v[44:47], v62 offset:1552
    ds_read_b128 v[36:39], v61 offset:25344
    s_waitcnt lgkmcnt(6)
    v_mfma_f32_32x32x16_bf16 a[16:31], v[16:19], v[24:27], a[16:31]
    ds_read_b128 v[24:27], v62 offset:4000
    s_waitcnt lgkmcnt(6)
    v_mfma_f32_32x32x16_bf16 a[0:15], v[16:19], v[28:31], a[0:15]
    ds_read_b128 v[16:19], v60 offset:7488
    s_waitcnt lgkmcnt(6)
    v_mfma_f32_32x32x16_bf16 a[16:31], v[20:23], v[28:31], a[16:31]
    ds_read_b128 v[28:31], v62 offset:1440
    ds_read_b128 v[20:23], v60 offset:25920
    s_waitcnt lgkmcnt(6)
    v_mfma_f32_32x32x16_bf16 a[16:31], v[32:35], v[40:43], a[16:31]
    ds_read_b128 v[40:43], v62 offset:4032
    s_waitcnt lgkmcnt(6)
    v_mfma_f32_32x32x16_bf16 a[0:15], v[32:35], v[44:47], a[0:15]
    ds_read_b128 v[32:35], v61 offset:7488
    s_waitcnt lgkmcnt(6)
    v_mfma_f32_32x32x16_bf16 a[16:31], v[36:39], v[44:47], a[16:31]
    ds_read_b128 v[44:47], v62 offset:1472
    ds_read_b128 v[36:39], v61 offset:25920
    s_waitcnt lgkmcnt(6)
    v_mfma_f32_32x32x16_bf16 a[16:31], v[16:19], v[24:27], a[16:31]
    ds_read_b128 v[24:27], v62 offset:3920
    s_waitcnt lgkmcnt(6)
    v_mfma_f32_32x32x16_bf16 a[0:15], v[16:19], v[28:31], a[0:15]
    ds_read_b128 v[16:19], v60 offset:8064
    s_waitcnt lgkmcnt(6)
    v_mfma_f32_32x32x16_bf16 a[16:31], v[20:23], v[28:31], a[16:31]
    ds_read_b128 v[28:31], v62 offset:1360
    ds_read_b128 v[20:23], v60 offset:26496
    s_waitcnt lgkmcnt(6)
    v_mfma_f32_32x32x16_bf16 a[16:31], v[32:35], v[40:43], a[16:31]
    ds_read_b128 v[40:43], v62 offset:3952
    s_waitcnt lgkmcnt(6)
    v_mfma_f32_32x32x16_bf16 a[0:15], v[32:35], v[44:47], a[0:15]
    ds_read_b128 v[32:35], v61 offset:8064
    s_waitcnt lgkmcnt(6)
    v_mfma_f32_32x32x16_bf16 a[16:31], v[36:39], v[44:47], a[16:31]
    ds_read_b128 v[44:47], v62 offset:1392
    ds_read_b128 v[36:39], v61 offset:26496
    s_waitcnt lgkmcnt(6)
    v_mfma_f32_32x32x16_bf16 a[16:31], v[16:19], v[24:27], a[16:31]
    ds_read_b128 v[24:27], v62 offset:3840
    s_waitcnt lgkmcnt(6)
    v_mfma_f32_32x32x16_bf16 a[0:15], v[16:19], v[28:31], a[0:15]
    ds_read_b128 v[16:19], v60 offset:8640
    s_waitcnt lgkmcnt(6)
    v_mfma_f32_32x32x16_bf16 a[16:31], v[20:23], v[28:31], a[16:31]
    ds_read_b128 v[28:31], v62 offset:1280
    ds_read_b128 v[20:23], v60 offset:27072
    s_waitcnt lgkmcnt(6)
    v_mfma_f32_32x32x16_bf16 a[16:31], v[32:35], v[40:43], a[16:31]
    ds_read_b128 v[40:43], v62 offset:3872
    s_waitcnt lgkmcnt(6)
    v_mfma_f32_32x32x16_bf16 a[0:15], v[32:35], v[44:47], a[0:15]
    ds_read_b128 v[32:35], v61 offset:8640
    s_waitcnt lgkmcnt(6)
    v_mfma_f32_32x32x16_bf16 a[16:31], v[36:39], v[44:47], a[16:31]
    ds_read_b128 v[44:47], v62 offset:1312
    ds_read_b128 v[36:39], v61 offset:27072
    s_waitcnt lgkmcnt(6)
    v_mfma_f32_32x32x16_bf16 a[16:31], v[16:19], v[24:27], a[16:31]
    s_waitcnt lgkmcnt(5)
    v_mfma_f32_32x32x16_bf16 a[0:15], v[16:19], v[28:31], a[0:15]
    s_waitcnt lgkmcnt(4)
    v_mfma_f32_32x32x16_bf16 a[16:31], v[20:23], v[28:31], a[16:31]
    s_waitcnt lgkmcnt(2)
    v_mfma_f32_32x32x16_bf16 a[16:31], v[32:35], v[40:43], a[16:31]
    s_waitcnt lgkmcnt(1)
    v_mfma_f32_32x32x16_bf16 a[0:15], v[32:35], v[44:47], a[0:15]
    s_waitcnt lgkmcnt(0)
    v_mfma_f32_32x32x16_bf16 a[16:31], v[36:39], v[44:47], a[16:31]
    s_setprio 3
    s_mov_b32 s7, 0
    s_add_u32 s7, s7, 148900
    v_mov_b32 v10, s7
    v_mov_b32 v11, 1
    s_waitcnt lgkmcnt(0)
    s_mov_b64 exec, 1
    ds_add_u32 v10, v11
    s_mov_b64 exec, -1
    s_mov_b32 s98, 2097152
LSPIN_5:
    ds_read_b32 v14, v10 offset:0
    s_waitcnt lgkmcnt(0)
    v_cmp_le_u16 vcc, 4, v14
    s_cbranch_vccz RETRY_6
    s_lshl_b32 s7, s69, 13
    v_add_u32 v11, s7, v2
    v_lshrrev_b32 v8, 3, v1
    v_bfe_u32 v9, v1, 2, 1
    v_bfe_u32 v10, v1, 1, 1
    v_and_b32 v13, 1, v1
    v_lshlrev_b32 v48, 4, v8
    v_lshl_add_u32 v48, v9, 14, v48
    v_lshl_add_u32 v48, v10, 11, v48
    v_lshl_add_u32 v48, v13, 9, v48
    s_lshr_b32 s7, s69, 1
    s_lshl_b32 s7, s7, 12
    s_lshl_b32 s8, s89, 4
    s_add_u32 s7, s7, s8
    v_add_u32 v48, s7, v48
    s_waitcnt lgkmcnt(0)
    ds_write_b128 v11, a[0:3] offset:0
    ds_write_b128 v11, a[4:7] offset:1024
    ds_write_b128 v11, a[8:11] offset:2048
    ds_write_b128 v11, a[12:15] offset:3072
    ds_write_b128 v11, a[16:19] offset:4096
    ds_write_b128 v11, a[20:23] offset:5120
    ds_write_b128 v11, a[24:27] offset:6144
    ds_write_b128 v11, a[28:31] offset:7168
    v_mul_u32_u24 v49, 28672, v8
    v_and_b32 v9, 7, v1
    v_lshl_add_u32 v49, v9, 4, v49
    s_mul_i32 s9, s69, 458752
    s_lshl_b32 s8, s2, 7
    s_add_u32 s9, s9, s8
    s_add_u32 s9, s9, 0x840000
    s_mov_b32 s7, 0
    s_add_u32 s7, s7, 148880
    v_mov_b32 v10, s7
    v_mov_b32 v11, 1
    s_waitcnt lgkmcnt(0)
    s_mov_b64 exec, 1
    ds_add_u32 v10, v11
    s_mov_b64 exec, -1
    s_mov_b32 s98, 2097152
LSPIN_7:
    ds_read_b32 v14, v10 offset:0
    s_waitcnt lgkmcnt(0)
    v_cmp_le_u16 vcc, 4, v14
    s_cbranch_vccz RETRY_8
    ds_read_b128 v[16:19], v48 offset:0
    ds_read_b128 v[20:23], v48 offset:1024
    ds_read_b128 v[24:27], v48 offset:8192
    ds_read_b128 v[28:31], v48 offset:9216
    ds_read_b128 v[32:35], v48 offset:128
    ds_read_b128 v[36:39], v48 offset:1152
    ds_read_b128 v[40:43], v48 offset:8320
    ds_read_b128 v[44:47], v48 offset:9344
    s_waitcnt lgkmcnt(4)
    v_add_f32 v16, v16, v24
    v_add_f32 v17, v17, v25
    v_add_f32 v18, v18, v26
    v_add_f32 v19, v19, v27
    v_add_f32 v20, v20, v28
    v_add_f32 v21, v21, v29
    v_add_f32 v22, v22, v30
    v_add_f32 v23, v23, v31
    v_cvt_pk_bf16_f32 v24, v16, v17
    v_cvt_pk_bf16_f32 v25, v18, v19
    v_cvt_pk_bf16_f32 v26, v20, v21
    v_cvt_pk_bf16_f32 v27, v22, v23
    s_waitcnt lgkmcnt(0)
    v_add_f32 v32, v32, v40
    v_add_f32 v33, v33, v41
    v_add_f32 v34, v34, v42
    v_add_f32 v35, v35, v43
    v_add_f32 v36, v36, v44
    v_add_f32 v37, v37, v45
    v_add_f32 v38, v38, v46
    v_add_f32 v39, v39, v47
    v_cvt_pk_bf16_f32 v40, v32, v33
    v_cvt_pk_bf16_f32 v41, v34, v35
    v_cvt_pk_bf16_f32 v42, v36, v37
    v_cvt_pk_bf16_f32 v43, v38, v39
    s_mov_b32 s98, 2097152
    v_mov_b32 v13, 148864
LSPIN_9:
    ds_read_b32 v14, v13 offset:4
    s_waitcnt lgkmcnt(0)
    v_cmp_le_u16 vcc, 1, v14
    s_cbranch_vccz RETRY_10
    buffer_store_dwordx4 v[24:27], v49, s[44:47], s9 offen sc1
    s_add_u32 s9, s9, 229376
    buffer_store_dwordx4 v[40:43], v49, s[44:47], s9 offen sc1
    s_lshl_b32 s7, s2, 2
    s_add_u32 s7, s7, s69
    s_lshl_b32 s7, s7, 7
    s_add_u32 s77, s7, 0xd10000
L_C_DONE:
    s_setprio 3
    s_mov_b32 s98, 2097152
    v_mov_b32 v13, 148864
LSPIN_11:
    ds_read_b32 v14, v13 offset:4
    s_waitcnt lgkmcnt(0)
    v_cmp_le_u16 vcc, 1, v14
    s_cbranch_vccz RETRY_12
    s_mov_b32 s48, s16
    s_mov_b32 s49, s17
    s_mov_b32 s50, 0x1c0000
    s_mov_b32 s51, 0x00020000
    v_mov_b32 v14, 0x7fff0000
    s_mov_b32 s7, 0x7fff0000
    s_cmp_eq_u32 s69, 3
    s_cbranch_scc0 L_P_PUB
    s_mov_b32 s56, s34
    s_mov_b32 s57, s35
    s_mov_b32 s58, 0x380
    s_mov_b32 s59, 0x00020000
    v_and_b32 v10, 7, v1
    v_lshlrev_b32 v10, 4, v10
    v_mul_u32_u24 v11, 896, v6
    v_add_u32 v11, v11, v10
    s_mul_i32 s9, s2, 7168
    buffer_load_dwordx4 v[64:67], v11, s[48:51], s9 offen offset:0
    buffer_load_dwordx4 v[68:71], v11, s[48:51], s9 offen offset:128
    buffer_load_dwordx4 v[72:75], v11, s[48:51], s9 offen offset:256
    buffer_load_dwordx4 v[76:79], v11, s[48:51], s9 offen offset:384
    buffer_load_dwordx4 v[80:83], v11, s[48:51], s9 offen offset:512
    buffer_load_dwordx4 v[84:87], v11, s[48:51], s9 offen offset:640
    buffer_load_dwordx4 v[88:91], v11, s[48:51], s9 offen offset:768
    buffer_load_dwordx4 v[92:95], v10, s[56:59], 0 offen offset:0
    buffer_load_dwordx4 v[96:99], v10, s[56:59], 0 offen offset:128
    buffer_load_dwordx4 v[100:103], v10, s[56:59], 0 offen offset:256
    buffer_load_dwordx4 v[104:107], v10, s[56:59], 0 offen offset:384
    buffer_load_dwordx4 v[108:111], v10, s[56:59], 0 offen offset:512
    buffer_load_dwordx4 v[112:115], v10, s[56:59], 0 offen offset:640
    buffer_load_dwordx4 v[116:119], v10, s[56:59], 0 offen offset:768
    v_mov_b32 v120, 0
    s_waitcnt vmcnt(0)
    v_dot2_f32_bf16 v120, v64, v92, v120
    v_dot2_f32_bf16 v120, v65, v93, v120
    v_dot2_f32_bf16 v120, v66, v94, v120
    v_dot2_f32_bf16 v120, v67, v95, v120
    v_dot2_f32_bf16 v120, v68, v96, v120
    v_dot2_f32_bf16 v120, v69, v97, v120
    v_dot2_f32_bf16 v120, v70, v98, v120
    v_dot2_f32_bf16 v120, v71, v99, v120
    v_dot2_f32_bf16 v120, v72, v100, v120
    v_dot2_f32_bf16 v120, v73, v101, v120
    v_dot2_f32_bf16 v120, v74, v102, v120
    v_dot2_f32_bf16 v120, v75, v103, v120
    v_dot2_f32_bf16 v120, v76, v104, v120
    v_dot2_f32_bf16 v120, v77, v105, v120
    v_dot2_f32_bf16 v120, v78, v106, v120
    v_dot2_f32_bf16 v120, v79, v107, v120
    v_dot2_f32_bf16 v120, v80, v108, v120
    v_dot2_f32_bf16 v120, v81, v109, v120
    v_dot2_f32_bf16 v120, v82, v110, v120
    v_dot2_f32_bf16 v120, v83, v111, v120
    v_dot2_f32_bf16 v120, v84, v112, v120
    v_dot2_f32_bf16 v120, v85, v113, v120
    v_dot2_f32_bf16 v120, v86, v114, v120
    v_dot2_f32_bf16 v120, v87, v115, v120
    v_dot2_f32_bf16 v120, v88, v116, v120
    v_dot2_f32_bf16 v120, v89, v117, v120
    v_dot2_f32_bf16 v120, v90, v118, v120
    v_dot2_f32_bf16 v120, v91, v119, v120
    s_nop 3
    v_add_f32_dpp v120, v120, v120 quad_perm:[1,0,3,2] row_mask:0xf bank_mask:0xf
    s_nop 1
    v_add_f32_dpp v120, v120, v120 quad_perm:[2,3,0,1] row_mask:0xf bank_mask:0xf
    s_nop 1
    v_add_f32_dpp v120, v120, v120 row_half_mirror row_mask:0xf bank_mask:0xf
    v_mul_f32 v120, 0xbfb8aa3b, v120
    v_exp_f32 v120, v120
    v_lshlrev_b32 v121, 2, v6
    v_add_f32 v120, 1.0, v120
    v_rcp_f32 v120, v120
    s_lshl_b32 s9, s2, 5
    s_add_u32 s9, s9, 0xc80000
    buffer_store_dword v120, v121, s[44:47], s9 offen sc1
    s_lshl_b32 s7, s2, 7
    s_add_u32 s7, s7, 0xce8000
L_P_PUB:
    v_mov_b32 v48, s68
    v_mov_b32 v49, s68
    v_mov_b32 v50, s68
    v_mov_b32 v51, s68
    s_getreg_b32 s8, hwreg(HW_REG_XCC_ID)
    v_mov_b32 v49, s8
    s_waitcnt vmcnt(0)
    s_mov_b64 exec, 0xff
    buffer_store_dwordx4 v[48:51], v2, s[44:47], s7 offen sc1
    s_mov_b64 exec, -1
    s_mov_b64 exec, 0xff
    buffer_store_dwordx4 v[48:51], v2, s[44:47], s77 offen sc1
    s_mov_b64 exec, -1
    s_lshr_b32 s7, s70, 2
    s_lshl_b32 s7, s7, 2
    s_add_u32 s80, s7, s69
    s_and_b32 s7, s70, 3
    s_lshl_b32 s82, s71, 2
    s_add_u32 s82, s82, s7
    s_mul_i32 s83, s82, 28672
    s_lshl_b32 s7, s80, 6
    s_add_u32 s81, s83, s7
    v_mul_u32_u24 v7, 896, v4
    v_lshl_add_u32 v7, v5, 4, v7
    s_cmp_ge_u32 s80, 14
    s_cbranch_scc1 L_O_SKIP
    s_lshl_b32 s8, s80, 10
    s_add_u32 s8, s8, 0xce0000
    s_mov_b32 s98, 131072
    s_mov_b64 exec, 0xff
POLL_13:
    buffer_load_dword v13, v12, s[44:47], s8 offen sc1
    s_waitcnt vmcnt(0)
    v_cmp_ne_u32 vcc, s68, v13
    s_cbranch_vccnz RETRY_14
    s_mov_b64 exec, -1
    s_lshl_b32 s8, s80, 15
    s_add_u32 s8, s8, 0xc00000
    buffer_load_dwordx4 a[0:3], v2, s[44:47], s8 offen offset:0 sc1
    buffer_load_dwordx4 a[4:7], v2, s[44:47], s8 offen offset:1024 sc1
    buffer_load_dwordx4 a[8:11], v2, s[44:47], s8 offen offset:2048 sc1
    buffer_load_dwordx4 a[12:15], v2, s[44:47], s8 offen offset:3072 sc1
    s_waitcnt vmcnt(2)
    s_lshl_b32 s8, s80, 15
    s_add_u32 s8, s8, 0xc01000
    buffer_load_dwordx4 a[16:19], v2, s[44:47], s8 offen offset:0 sc1
    buffer_load_dwordx4 a[20:23], v2, s[44:47], s8 offen offset:1024 sc1
    buffer_load_dwordx4 a[24:27], v2, s[44:47], s8 offen offset:2048 sc1
    buffer_load_dwordx4 a[28:31], v2, s[44:47], s8 offen offset:3072 sc1
    s_waitcnt vmcnt(2)
    s_lshl_b32 s8, s80, 15
    s_add_u32 s8, s8, 0xc02000
    buffer_load_dwordx4 a[32:35], v2, s[44:47], s8 offen offset:0 sc1
    buffer_load_dwordx4 a[36:39], v2, s[44:47], s8 offen offset:1024 sc1
    buffer_load_dwordx4 a[40:43], v2, s[44:47], s8 offen offset:2048 sc1
    buffer_load_dwordx4 a[44:47], v2, s[44:47], s8 offen offset:3072 sc1
    s_waitcnt vmcnt(2)
    s_lshl_b32 s8, s80, 15
    s_add_u32 s8, s8, 0xc03000
    buffer_load_dwordx4 a[48:51], v2, s[44:47], s8 offen offset:0 sc1
    buffer_load_dwordx4 a[52:55], v2, s[44:47], s8 offen offset:1024 sc1
    buffer_load_dwordx4 a[56:59], v2, s[44:47], s8 offen offset:2048 sc1
    buffer_load_dwordx4 a[60:63], v2, s[44:47], s8 offen offset:3072 sc1
    s_waitcnt vmcnt(2)
    s_lshl_b32 s8, s80, 15
    s_add_u32 s8, s8, 0xc04000
    buffer_load_dwordx4 v[64:67], v2, s[44:47], s8 offen offset:0 sc1
    buffer_load_dwordx4 v[68:71], v2, s[44:47], s8 offen offset:1024 sc1
    buffer_load_dwordx4 v[72:75], v2, s[44:47], s8 offen offset:2048 sc1
    buffer_load_dwordx4 v[76:79], v2, s[44:47], s8 offen offset:3072 sc1
    s_waitcnt vmcnt(2)
    s_lshl_b32 s8, s80, 15
    s_add_u32 s8, s8, 0xc05000
    buffer_load_dwordx4 v[80:83], v2, s[44:47], s8 offen offset:0 sc1
    buffer_load_dwordx4 v[84:87], v2, s[44:47], s8 offen offset:1024 sc1
    buffer_load_dwordx4 v[88:91], v2, s[44:47], s8 offen offset:2048 sc1
    buffer_load_dwordx4 v[92:95], v2, s[44:47], s8 offen offset:3072 sc1
    s_waitcnt vmcnt(2)
    s_lshl_b32 s8, s80, 15
    s_add_u32 s8, s8, 0xc06000
    buffer_load_dwordx4 v[96:99], v2, s[44:47], s8 offen offset:0 sc1
    buffer_load_dwordx4 v[100:103], v2, s[44:47], s8 offen offset:1024 sc1
    buffer_load_dwordx4 v[104:107], v2, s[44:47], s8 offen offset:2048 sc1
    buffer_load_dwordx4 v[108:111], v2, s[44:47], s8 offen offset:3072 sc1
    s_waitcnt vmcnt(2)
    s_lshl_b32 s8, s80, 15
    s_add_u32 s8, s8, 0xc07000
    buffer_load_dwordx4 v[112:115], v2, s[44:47], s8 offen offset:0 sc1
    buffer_load_dwordx4 v[116:119], v2, s[44:47], s8 offen offset:1024 sc1
    buffer_load_dwordx4 v[120:123], v2, s[44:47], s8 offen offset:2048 sc1
    buffer_load_dwordx4 v[124:127], v2, s[44:47], s8 offen offset:3072 sc1
    s_waitcnt vmcnt(2)
    s_lshl_b32 s9, s80, 6
    s_lshr_b32 s10, s82, 4
    s_add_u32 s9, s9, s10
    s_lshl_b32 s9, s9, 7
    s_add_u32 s9, s9, 0xd10000
    s_lshl_b32 s10, s82, 9
    s_add_u32 s10, s10, 0xce8000
    s_and_b32 s11, s2, 15
    s_lshl_b32 s11, s11, 7
    s_add_u32 s11, s11, 0xce8000
    v_and_b32 v8, 15, v1
    v_lshl_add_u32 v12, v8, 9, s9
    s_mov_b32 exec_lo, 0
    v_lshl_add_u32 v12, v8, 7, s10
    s_mov_b32 exec_hi, 0xffff0000
    v_lshl_add_u32 v12, v8, 11, s11
    s_mov_b64 exec, -1
    s_getreg_b32 s9, hwreg(HW_REG_XCC_ID)
    v_and_b32 v11, 4, v4
    v_and_b32 v13, 8, v4
    v_and_b32 v10, 0x13, v4
    v_lshl_or_b32 v10, v11, 1, v10
    v_lshrrev_b32 v13, 1, v13
    v_or_b32 v10, v10, v13
    v_lshlrev_b32 v10, 6, v10
    v_lshl_add_u32 v10, v5, 4, v10
    v_lshlrev_b32 v11, 2, v4
    buffer_load_dwordx4 v[40:43], v7, s[48:51], s81 offen
    buffer_load_dwordx4 v[44:47], v7, s[48:51], s81 offen offset:32
    s_waitcnt vmcnt(0)
    s_mov_b32 s98, 131072
    s_mov_b32 exec_lo, 0xffff
    s_mov_b32 exec_hi, 0xffff000f
FPOLL_15:
    buffer_load_dwordx2 v[56:57], v12, s[44:47], 0 offen sc1
    s_waitcnt vmcnt(0)
    v_cmp_ne_u32 vcc, s68, v56
    s_cbranch_vccnz RETRY_16
    s_mov_b64 exec, -1
    s_lshl_b32 s7, s80, 11
    s_add_u32 s7, s7, s83
    s_add_u32 s7, s7, 0x840000
    buffer_load_dwordx4 v[32:35], v10, s[44:47], s7 offen sc1
    buffer_load_dwordx4 v[36:39], v10, s[44:47], s7 offen offset:32 sc1
    s_lshl_b32 s7, s82, 7
    s_add_u32 s7, s7, 0xc80000
    buffer_load_dword v6, v11, s[44:47], s7 offen sc1
    v_cmp_ne_u32 vcc, s9, v57
    s_lshr_b32 s7, vcc_hi, 16
    s_cmp_eq_u32 s7, 0
    s_cselect_b32 s7, 1, 0
    v_mov_b32 v12, 148864
    v_mov_b32 v13, s7
    s_mov_b64 exec, 1
    ds_write_b32 v12, v13 offset:24
    s_mov_b64 exec, -1
L_O_DONE:
    s_waitcnt lgkmcnt(0)
    v_lshlrev_b32 v12, 7, v1
    s_lshl_b32 s8, s82, 2
    s_add_u32 s8, s8, s69
    s_lshl_b32 s8, s8, 9
    s_add_u32 s8, s8, 0xcf0000
    s_mov_b64 exec, 15
    buffer_load_dword v13, v12, s[44:47], s8 offen sc1
    s_mov_b64 exec, -1
    s_setprio 0
    s_waitcnt vmcnt(0)
    s_barrier
    s_mov_b32 s56, s36
    s_mov_b32 s57, s37
    s_mov_b32 s58, 0x1c0000
    s_mov_b32 s59, 0x00020000
    v_lshrrev_b32 v10, 3, v4
    v_bfe_u32 v11, v4, 1, 1
    v_lshl_or_b32 v10, v10, 1, v11
    v_bfe_u32 v11, v4, 2, 1
    v_cmp_eq_u32 vcc, v11, v5
    v_and_b32 v12, 1, v4
    v_lshlrev_b32 v12, 4, v12
    v_cndmask_b32 v10, 63, v10, vcc
    v_mov_b32 v13, 0x3f80
    v_lshlrev_b32 v12, v12, v13
    v_cmp_eq_u32 vcc, 0, v10
    s_nop 1
    v_cndmask_b32 v48, 0, v12, vcc
    v_cmp_eq_u32 vcc, 1, v10
    s_nop 1
    v_cndmask_b32 v49, 0, v12, vcc
    v_cmp_eq_u32 vcc, 2, v10
    s_nop 1
    v_cndmask_b32 v50, 0, v12, vcc
    v_cmp_eq_u32 vcc, 3, v10
    s_nop 1
    v_cndmask_b32 v51, 0, v12, vcc
    v_cmp_eq_u32 vcc, 4, v10
    s_nop 1
    v_cndmask_b32 v52, 0, v12, vcc
    v_cmp_eq_u32 vcc, 5, v10
    s_nop 1
    v_cndmask_b32 v53, 0, v12, vcc
    v_cmp_eq_u32 vcc, 6, v10
    s_nop 1
    v_cndmask_b32 v54, 0, v12, vcc
    v_cmp_eq_u32 vcc, 7, v10
    s_nop 1
    v_cndmask_b32 v55, 0, v12, vcc
    s_mov_b32 s15, 0xffff0000
    s_nop 0
    v_mfma_f32_32x32x16_bf16 v[16:31], v[32:35], v[48:51], 0
    v_mfma_f32_32x32x16_bf16 v[16:31], v[36:39], v[52:55], v[16:31]
    v_lshlrev_b32 v128, 16, v40
    v_and_b32 v129, s15, v40
    v_lshlrev_b32 v130, 16, v41
    v_and_b32 v131, s15, v41
    v_lshlrev_b32 v132, 16, v42
    v_and_b32 v133, s15, v42
    v_lshlrev_b32 v134, 16, v43
    v_and_b32 v135, s15, v43
    v_lshlrev_b32 v136, 16, v44
    v_and_b32 v137, s15, v44
    v_lshlrev_b32 v138, 16, v45
    v_and_b32 v139, s15, v45
    v_lshlrev_b32 v140, 16, v46
    v_and_b32 v141, s15, v46
    v_lshlrev_b32 v142, 16, v47
    v_and_b32 v143, s15, v47
    v_mul_f32 v128, v6, v128
    v_mul_f32 v129, v6, v129
    v_mul_f32 v130, v6, v130
    v_mul_f32 v131, v6, v131
    v_mul_f32 v132, v6, v132
    v_mul_f32 v133, v6, v133
    v_mul_f32 v134, v6, v134
    v_mul_f32 v135, v6, v135
    v_mul_f32 v136, v6, v136
    v_mul_f32 v137, v6, v137
    v_mul_f32 v138, v6, v138
    v_mul_f32 v139, v6, v139
    v_mul_f32 v140, v6, v140
    v_mul_f32 v141, v6, v141
    v_mul_f32 v142, v6, v142
    v_mul_f32 v143, v6, v143
    v_mul_f32 v128, v128, v16
    v_mul_f32 v129, v129, v17
    v_mul_f32 v130, v130, v18
    v_mul_f32 v131, v131, v19
    v_mul_f32 v132, v132, v20
    v_mul_f32 v133, v133, v21
    v_mul_f32 v134, v134, v22
    v_mul_f32 v135, v135, v23
    v_mul_f32 v136, v136, v24
    v_mul_f32 v137, v137, v25
    v_mul_f32 v138, v138, v26
    v_mul_f32 v139, v139, v27
    v_mul_f32 v140, v140, v28
    v_mul_f32 v141, v141, v29
    v_mul_f32 v142, v142, v30
    v_mul_f32 v143, v143, v31
    v_sub_f32 v6, 1.0, v6
    v_lshlrev_b32 v12, 7, v1
    s_lshl_b32 s8, s82, 2
    s_add_u32 s8, s8, s69
    s_lshl_b32 s10, s8, 13
    s_add_u32 s10, s10, 0xa00000
    s_lshl_b32 s8, s8, 9
    s_add_u32 s8, s8, 0xcf0000
    s_lshl_b32 s7, s69, 13
    s_mov_b32 m0, s7
    v_mul_u32_u24 v8, 272, v4
    v_lshl_add_u32 v8, v5, 4, v8
    s_lshl_b32 s9, s69, 6
    s_add_u32 s9, s9, 40960
    v_add_u32 v8, s9, v8
    v_lshrrev_b32 v10, 3, v1
    v_and_b32 v11, 7, v1
    v_mul_u32_u24 v9, 272, v10
    v_lshl_add_u32 v9, v11, 4, v9
    s_and_b32 s9, s69, 1
    s_mul_i32 s11, s9, 4352
    s_lshr_b32 s12, s69, 1
    s_lshl_b32 s12, s12, 7
    s_add_u32 s11, s11, s12
    s_add_u32 s11, s11, 40960
    v_add_u32 v9, s11, v9
    v_mul_u32_u24 v10, 896, v10
    v_lshl_add_u32 v10, v11, 4, v10
    s_mul_i32 s84, s9, 14272
    s_add_u32 s84, s84, s81
    s_add_u32 s85, s84, 7168
    s_barrier
    s_mov_b32 s98, 131072
    s_mov_b64 exec, 15
POLL_17:
    buffer_load_dword v13, v12, s[44:47], s8 offen sc1
    s_waitcnt vmcnt(0)
    v_cmp_ne_u32 vcc, s68, v13
    s_cbranch_vccnz RETRY_18
    s_mov_b64 exec, -1
    buffer_load_dwordx4 v2, s[44:47], s10 offen offset:0 sc1 lds
    buffer_load_dwordx4 v2, s[44:47], s10 offen offset:1024 sc1 lds
    buffer_load_dwordx4 v2, s[44:47], s10 offen offset:2048 sc1 lds
    buffer_load_dwordx4 v2, s[44:47], s10 offen offset:3072 sc1 lds
    s_add_u32 m0, s7, 4096
    s_add_u32 s10, s10, 4096
    buffer_load_dwordx4 v2, s[44:47], s10 offen offset:0 sc1 lds
    buffer_load_dwordx4 v2, s[44:47], s10 offen offset:1024 sc1 lds
    buffer_load_dwordx4 v2, s[44:47], s10 offen offset:2048 sc1 lds
    buffer_load_dwordx4 v2, s[44:47], s10 offen offset:3072 sc1 lds
    s_waitcnt vmcnt(0)
    s_barrier
    s_cmp_ge_u32 s80, 14
    s_cbranch_scc1 L_END
    ds_read_b128 v[32:35], v2 offset:0
    ds_read_b128 v[36:39], v2 offset:1024
    ds_read_b128 v[40:43], v2 offset:2048
    ds_read_b128 v[44:47], v2 offset:3072
    ds_read_b128 v[48:51], v2 offset:4096
    ds_read_b128 v[52:55], v2 offset:5120
    ds_read_b128 v[56:59], v2 offset:6144
    ds_read_b128 v[60:63], v2 offset:7168
    s_waitcnt lgkmcnt(7)
    v_mfma_f32_32x32x16_bf16 v[16:31], a[0:3], v[32:35], 0
    ds_read_b128 v[32:35], v2 offset:8192
    s_waitcnt lgkmcnt(7)
    v_mfma_f32_32x32x16_bf16 v[16:31], a[4:7], v[36:39], v[16:31]
    ds_read_b128 v[36:39], v2 offset:9216
    s_waitcnt lgkmcnt(7)
    v_mfma_f32_32x32x16_bf16 v[16:31], a[8:11], v[40:43], v[16:31]
    ds_read_b128 v[40:43], v2 offset:10240
    s_waitcnt lgkmcnt(7)
    v_mfma_f32_32x32x16_bf16 v[16:31], a[12:15], v[44:47], v[16:31]
    ds_read_b128 v[44:47], v2 offset:11264
    s_waitcnt lgkmcnt(7)
    v_mfma_f32_32x32x16_bf16 v[16:31], a[16:19], v[48:51], v[16:31]
    ds_read_b128 v[48:51], v2 offset:12288
    s_waitcnt lgkmcnt(7)
    v_mfma_f32_32x32x16_bf16 v[16:31], a[20:23], v[52:55], v[16:31]
    ds_read_b128 v[52:55], v2 offset:13312
    s_waitcnt lgkmcnt(7)
    v_mfma_f32_32x32x16_bf16 v[16:31], a[24:27], v[56:59], v[16:31]
    ds_read_b128 v[56:59], v2 offset:14336
    s_waitcnt lgkmcnt(7)
    v_mfma_f32_32x32x16_bf16 v[16:31], a[28:31], v[60:63], v[16:31]
    ds_read_b128 v[60:63], v2 offset:15360
    s_waitcnt lgkmcnt(7)
    v_mfma_f32_32x32x16_bf16 v[16:31], a[32:35], v[32:35], v[16:31]
    ds_read_b128 v[32:35], v2 offset:16384
    s_waitcnt lgkmcnt(7)
    v_mfma_f32_32x32x16_bf16 v[16:31], a[36:39], v[36:39], v[16:31]
    ds_read_b128 v[36:39], v2 offset:17408
    s_waitcnt lgkmcnt(7)
    v_mfma_f32_32x32x16_bf16 v[16:31], a[40:43], v[40:43], v[16:31]
    ds_read_b128 v[40:43], v2 offset:18432
    s_waitcnt lgkmcnt(7)
    v_mfma_f32_32x32x16_bf16 v[16:31], a[44:47], v[44:47], v[16:31]
    ds_read_b128 v[44:47], v2 offset:19456
    s_waitcnt lgkmcnt(7)
    v_mfma_f32_32x32x16_bf16 v[16:31], a[48:51], v[48:51], v[16:31]
    ds_read_b128 v[48:51], v2 offset:20480
    s_waitcnt lgkmcnt(7)
    v_mfma_f32_32x32x16_bf16 v[16:31], a[52:55], v[52:55], v[16:31]
    ds_read_b128 v[52:55], v2 offset:21504
    s_waitcnt lgkmcnt(7)
    v_mfma_f32_32x32x16_bf16 v[16:31], a[56:59], v[56:59], v[16:31]
    ds_read_b128 v[56:59], v2 offset:22528
    s_waitcnt lgkmcnt(7)
    v_mfma_f32_32x32x16_bf16 v[16:31], a[60:63], v[60:63], v[16:31]
    ds_read_b128 v[60:63], v2 offset:23552
    s_waitcnt lgkmcnt(7)
    v_mfma_f32_32x32x16_bf16 v[16:31], v[64:67], v[32:35], v[16:31]
    ds_read_b128 v[32:35], v2 offset:24576
    s_waitcnt lgkmcnt(7)
    v_mfma_f32_32x32x16_bf16 v[16:31], v[68:71], v[36:39], v[16:31]
    ds_read_b128 v[36:39], v2 offset:25600
    s_waitcnt lgkmcnt(7)
    v_mfma_f32_32x32x16_bf16 v[16:31], v[72:75], v[40:43], v[16:31]
    ds_read_b128 v[40:43], v2 offset:26624
    s_waitcnt lgkmcnt(7)
    v_mfma_f32_32x32x16_bf16 v[16:31], v[76:79], v[44:47], v[16:31]
    ds_read_b128 v[44:47], v2 offset:27648
    s_waitcnt lgkmcnt(7)
    v_mfma_f32_32x32x16_bf16 v[16:31], v[80:83], v[48:51], v[16:31]
    ds_read_b128 v[48:51], v2 offset:28672
    s_waitcnt lgkmcnt(7)
    v_mfma_f32_32x32x16_bf16 v[16:31], v[84:87], v[52:55], v[16:31]
    ds_read_b128 v[52:55], v2 offset:29696
    s_waitcnt lgkmcnt(7)
    v_mfma_f32_32x32x16_bf16 v[16:31], v[88:91], v[56:59], v[16:31]
    ds_read_b128 v[56:59], v2 offset:30720
    s_waitcnt lgkmcnt(7)
    v_mfma_f32_32x32x16_bf16 v[16:31], v[92:95], v[60:63], v[16:31]
    ds_read_b128 v[60:63], v2 offset:31744
    s_waitcnt lgkmcnt(7)
    v_mfma_f32_32x32x16_bf16 v[16:31], v[96:99], v[32:35], v[16:31]
    s_waitcnt lgkmcnt(6)
    v_mfma_f32_32x32x16_bf16 v[16:31], v[100:103], v[36:39], v[16:31]
    s_waitcnt lgkmcnt(5)
    v_mfma_f32_32x32x16_bf16 v[16:31], v[104:107], v[40:43], v[16:31]
    s_waitcnt lgkmcnt(4)
    v_mfma_f32_32x32x16_bf16 v[16:31], v[108:111], v[44:47], v[16:31]
    s_waitcnt lgkmcnt(3)
    v_mfma_f32_32x32x16_bf16 v[16:31], v[112:115], v[48:51], v[16:31]
    s_waitcnt lgkmcnt(2)
    v_mfma_f32_32x32x16_bf16 v[16:31], v[116:119], v[52:55], v[16:31]
    s_waitcnt lgkmcnt(1)
    v_mfma_f32_32x32x16_bf16 v[16:31], v[120:123], v[56:59], v[16:31]
    s_waitcnt lgkmcnt(0)
    v_mfma_f32_32x32x16_bf16 v[16:31], v[124:127], v[60:63], v[16:31]
    s_nop 7
    s_nop 3
    v_fmac_f32 v128, v6, v16
    v_fmac_f32 v129, v6, v17
    v_fmac_f32 v130, v6, v18
    v_fmac_f32 v131, v6, v19
    v_fmac_f32 v132, v6, v20
    v_fmac_f32 v133, v6, v21
    v_fmac_f32 v134, v6, v22
    v_fmac_f32 v135, v6, v23
    v_cvt_pk_bf16_f32 v32, v128, v129
    v_cvt_pk_bf16_f32 v33, v130, v131
    v_cvt_pk_bf16_f32 v34, v132, v133
    v_cvt_pk_bf16_f32 v35, v134, v135
    ds_write_b128 v8, v[32:35] offset:0
    v_fmac_f32 v136, v6, v24
    v_fmac_f32 v137, v6, v25
    v_fmac_f32 v138, v6, v26
    v_fmac_f32 v139, v6, v27
    v_fmac_f32 v140, v6, v28
    v_fmac_f32 v141, v6, v29
    v_fmac_f32 v142, v6, v30
    v_fmac_f32 v143, v6, v31
    v_cvt_pk_bf16_f32 v36, v136, v137
    v_cvt_pk_bf16_f32 v37, v138, v139
    v_cvt_pk_bf16_f32 v38, v140, v141
    v_cvt_pk_bf16_f32 v39, v142, v143
    ds_write_b128 v8, v[36:39] offset:32
    s_waitcnt lgkmcnt(0)
    s_barrier
    ds_read_b128 v[32:35], v9
    ds_read_b128 v[36:39], v9 offset:2176
    s_waitcnt lgkmcnt(1)
    buffer_store_dwordx4 v[32:35], v10, s[56:59], s84 offen nt
    s_waitcnt lgkmcnt(0)
    buffer_store_dwordx4 v[36:39], v10, s[56:59], s85 offen nt
    s_endpgm
L_O_SKIP:
    s_lshl_b32 s7, s2, 3
    s_add_u32 s7, s7, s3
    s_cmp_lg_u32 s7, 2042
    s_cbranch_scc1 L_O_DONE
    s_mov_b32 s8, 0xce8000
    s_mov_b32 s98, 131072
    s_mov_b64 exec, -1
POLL_19:
    buffer_load_dword v13, v12, s[44:47], s8 offen sc1
    s_waitcnt vmcnt(0)
    v_cmp_ne_u32 vcc, s68, v13
    s_cbranch_vccnz RETRY_20
    s_mov_b64 exec, -1
    s_mov_b32 s8, 0xcea000
    s_mov_b32 s98, 131072
    s_mov_b64 exec, -1
POLL_21:
    buffer_load_dword v13, v12, s[44:47], s8 offen sc1
    s_waitcnt vmcnt(0)
    v_cmp_ne_u32 vcc, s68, v13
    s_cbranch_vccnz RETRY_22
    s_mov_b64 exec, -1
    s_mov_b32 s8, 0xcec000
    s_mov_b32 s98, 131072
    s_mov_b64 exec, -1
POLL_23:
    buffer_load_dword v13, v12, s[44:47], s8 offen sc1
    s_waitcnt vmcnt(0)
    v_cmp_ne_u32 vcc, s68, v13
    s_cbranch_vccnz RETRY_24
    s_mov_b64 exec, -1
    s_mov_b32 s8, 0xcee000
    s_mov_b32 s98, 131072
    s_mov_b64 exec, -1
POLL_25:
    buffer_load_dword v13, v12, s[44:47], s8 offen sc1
    s_waitcnt vmcnt(0)
    v_cmp_ne_u32 vcc, s68, v13
    s_cbranch_vccnz RETRY_26
    s_mov_b64 exec, -1
    v_mov_b32 v13, s68
    s_mov_b32 s7, 0xca0000
    s_mov_b64 exec, 1
    buffer_store_dword v13, off, s[44:47], s7 sc1
    s_mov_b64 exec, -1
    s_branch L_O_DONE
L_WOPREP:
    s_cmp_ge_u32 s2, 252
    s_cbranch_scc1 L_C_DONE
    s_sub_u32 s8, s2, 224
    s_lshl_b32 s8, s8, 2
    s_add_u32 s8, s8, s69
    v_mov_b32 v14, 0x7fff0000
    s_mov_b32 s56, s32
    s_mov_b32 s57, s33
    s_mov_b32 s58, 0x62000
    s_mov_b32 s59, 0x00020000
    v_and_b32 v10, 4, v4
    v_and_b32 v13, 8, v4
    v_and_b32 v11, 0x13, v4
    v_lshl_or_b32 v11, v10, 1, v11
    v_lshrrev_b32 v13, 1, v13
    v_or_b32 v11, v11, v13
    v_mul_u32_u24 v13, 3584, v5
    v_lshl_add_u32 v11, v11, 1, v13
    v_cmp_eq_u32 vcc, 0, v5
    s_and_b32 s9, s8, 7
    s_lshr_b32 s10, s8, 3
    v_cndmask_b32 v10, v14, v11, vcc
    s_mul_i32 s11, s9, 50176
    s_lshl_b32 s12, s10, 6
    s_add_u32 s11, s11, s12
    buffer_load_ushort v64, v11, s[56:59], s11 offen offset:0
    buffer_load_ushort v65, v11, s[56:59], s11 offen offset:896
    buffer_load_ushort v66, v11, s[56:59], s11 offen offset:1792
    buffer_load_ushort v67, v11, s[56:59], s11 offen offset:2688
    s_add_u32 s11, s11, 7168
    buffer_load_ushort v68, v11, s[56:59], s11 offen offset:0
    buffer_load_ushort v69, v11, s[56:59], s11 offen offset:896
    buffer_load_ushort v70, v11, s[56:59], s11 offen offset:1792
    buffer_load_ushort v71, v11, s[56:59], s11 offen offset:2688
    s_add_u32 s11, s11, 7168
    buffer_load_ushort v72, v11, s[56:59], s11 offen offset:0
    buffer_load_ushort v73, v11, s[56:59], s11 offen offset:896
    buffer_load_ushort v74, v11, s[56:59], s11 offen offset:1792
    buffer_load_ushort v75, v11, s[56:59], s11 offen offset:2688
    s_add_u32 s11, s11, 7168
    buffer_load_ushort v76, v10, s[56:59], s11 offen offset:0
    buffer_load_ushort v77, v10, s[56:59], s11 offen offset:896
    buffer_load_ushort v78, v10, s[56:59], s11 offen offset:1792
    buffer_load_ushort v79, v10, s[56:59], s11 offen offset:2688
    s_add_u32 s11, s11, 3584
    buffer_load_ushort v80, v11, s[56:59], s11 offen offset:0
    buffer_load_ushort v81, v11, s[56:59], s11 offen offset:896
    buffer_load_ushort v82, v11, s[56:59], s11 offen offset:1792
    buffer_load_ushort v83, v11, s[56:59], s11 offen offset:2688
    s_add_u32 s11, s11, 7168
    buffer_load_ushort v84, v11, s[56:59], s11 offen offset:0
    buffer_load_ushort v85, v11, s[56:59], s11 offen offset:896
    buffer_load_ushort v86, v11, s[56:59], s11 offen offset:1792
    buffer_load_ushort v87, v11, s[56:59], s11 offen offset:2688
    s_add_u32 s11, s11, 7168
    buffer_load_ushort v88, v11, s[56:59], s11 offen offset:0
    buffer_load_ushort v89, v11, s[56:59], s11 offen offset:896
    buffer_load_ushort v90, v11, s[56:59], s11 offen offset:1792
    buffer_load_ushort v91, v11, s[56:59], s11 offen offset:2688
    s_add_u32 s11, s11, 7168
    buffer_load_ushort v92, v10, s[56:59], s11 offen offset:0
    buffer_load_ushort v93, v10, s[56:59], s11 offen offset:896
    buffer_load_ushort v94, v10, s[56:59], s11 offen offset:1792
    buffer_load_ushort v95, v10, s[56:59], s11 offen offset:2688
    s_add_u32 s11, s11, 3584
    s_waitcnt vmcnt(0)
    v_lshl_or_b32 v96, v65, 16, v64
    v_lshl_or_b32 v97, v67, 16, v66
    v_lshl_or_b32 v98, v69, 16, v68
    v_lshl_or_b32 v99, v71, 16, v70
    v_lshl_or_b32 v100, v73, 16, v72
    v_lshl_or_b32 v101, v75, 16, v74
    v_lshl_or_b32 v102, v77, 16, v76
    v_lshl_or_b32 v103, v79, 16, v78
    v_lshl_or_b32 v104, v81, 16, v80
    v_lshl_or_b32 v105, v83, 16, v82
    v_lshl_or_b32 v106, v85, 16, v84
    v_lshl_or_b32 v107, v87, 16, v86
    v_lshl_or_b32 v108, v89, 16, v88
    v_lshl_or_b32 v109, v91, 16, v90
    v_lshl_or_b32 v110, v93, 16, v92
    v_lshl_or_b32 v111, v95, 16, v94
    s_lshl_b32 s11, s8, 12
    s_add_u32 s11, s11, 0xc00000
    buffer_store_dwordx4 v[96:99], v2, s[44:47], s11 offen offset:0 sc1
    buffer_store_dwordx4 v[100:103], v2, s[44:47], s11 offen offset:1024 sc1
    buffer_store_dwordx4 v[104:107], v2, s[44:47], s11 offen offset:2048 sc1
    buffer_store_dwordx4 v[108:111], v2, s[44:47], s11 offen offset:3072 sc1
    s_lshl_b32 s7, s8, 7
    s_add_u32 s7, s7, 0xce0000
    v_mov_b32 v48, s68
    v_mov_b32 v49, s68
    v_mov_b32 v50, s68
    v_mov_b32 v51, s68
    s_waitcnt vmcnt(0)
    s_mov_b64 exec, 0xff
    buffer_store_dwordx4 v[48:51], v2, s[44:47], s7 offen sc1
    s_mov_b64 exec, -1
    s_branch L_C_DONE
L_MAIN:
    s_setprio 3
    s_waitcnt lgkmcnt(0)
    s_mov_b32 s44, s40
    s_mov_b32 s45, s41
    s_mov_b32 s46, 0xd30000
    s_mov_b32 s47, 0x00020000
    s_mov_b32 s56, s32
    s_mov_b32 s57, s33
    s_mov_b32 s58, 0x62000
    s_mov_b32 s59, 0x00020000
    s_lshl_b32 s7, s2, 2
    s_add_u32 s7, s7, s69
    s_lshl_b32 s7, s7, 9
    v_lshlrev_b32 v184, 7, v1
    s_mov_b64 exec, 15
    buffer_load_dword v185, v184, s[56:59], s7 offen
    s_mov_b64 exec, -1
    s_lshr_b32 s7, s2, 3
    s_lshl_b32 s7, s7, 2
    s_add_u32 s7, s7, s69
    s_mul_i32 s7, s7, 1536
    s_add_u32 s7, s7, 0xca1000
    v_lshlrev_b32 v184, 7, v1
    s_mov_b64 exec, 0xfff
    buffer_load_dword v183, v184, s[44:47], s7 offen sc1
    s_mov_b64 exec, -1
    s_mov_b32 s60, s16
    s_mov_b32 s61, s17
    s_mov_b32 s62, 0x1c0000
    s_mov_b32 s63, 0x00020000
    s_mov_b32 s48, s30
    s_mov_b32 s49, s31
    s_mov_b32 s50, 0x126000
    s_mov_b32 s51, 0x00020000
    s_lshl_b32 s7, s2, 2
    s_add_u32 s7, s7, s69
    s_mul_i32 s8, s7, 1792
    s_mul_i32 s9, s7, 1280
    v_lshlrev_b32 v184, 7, v1
    s_mov_b64 exec, 0x3fff
    buffer_load_dword v186, v184, s[60:63], s8 offen
    s_mov_b64 exec, 0x3ff
    buffer_load_dword v187, v184, s[48:51], s9 offen
    s_mov_b64 exec, -1
    s_mul_i32 s7, s70, 28
    s_add_u32 s8, s7, 27
    s_lshr_b32 s7, s7, 5
    s_lshr_b32 s8, s8, 5
    s_sub_u32 s8, s8, s7
    s_mul_i32 s7, s7, 22
    s_lshl_b32 s9, s69, 4
    s_mul_i32 s10, s9, 21846
    s_lshr_b32 s10, s10, 16
    s_add_u32 s9, s9, 15
    s_mul_i32 s11, s9, 21846
    s_lshr_b32 s11, s11, 16
    s_lshl_b32 s9, s71, 2
    s_mul_i32 s12, s9, 21846
    s_lshr_b32 s12, s12, 16
    s_add_u32 s9, s9, 3
    s_mul_i32 s13, s9, 21846
    s_lshr_b32 s13, s13, 16
    v_lshrrev_b32 v6, 4, v1
    v_bfe_u32 v7, v1, 3, 1
    v_and_b32 v8, 7, v1
    v_cmp_eq_u32 vcc, 2, v6
    v_mov_b32 v9, s10
    v_mov_b32 v10, s12
    v_cndmask_b32 v9, v9, v10, vcc
    v_mov_b32 v10, s11
    v_mov_b32 v11, s13
    v_cndmask_b32 v10, v10, v11, vcc
    v_add_u32 v9, v9, v8
    v_add_u32 v11, 1, v6
    v_cndmask_b32 v11, v11, 0, vcc
    v_mul_u32_u24 v11, 14, v11
    v_add_u32 v11, v11, v7
    v_mul_u32_u24 v11, 22, v11
    v_add_u32 v11, v11, v9
    v_cmp_le_u32 s[12:13], v9, v10
    v_cmp_ge_u32 vcc, s8, v7
    s_and_b64 s[12:13], s[12:13], vcc
    s_and_b32 s13, s13, 0xffff
    v_lshlrev_b32 v182, 7, v11
    s_lshl_b32 s7, s7, 7
    s_add_u32 s7, s7, 0xca1000
    v_add_u32 v182, s7, v182
    s_mov_b64 s[96:97], s[12:13]
    s_lshr_b32 s7, s71, 1
    s_mul_i32 s7, s7, 2
    s_and_b32 s7, s7, 15
    s_add_u32 s8, s7, 3
    s_and_b32 s8, s8, 15
    s_lshl_b32 s9, s69, 4
    s_add_u32 s10, s9, s7
    s_add_u32 s11, s9, s8
    s_mul_i32 s10, s10, 21846
    s_lshr_b32 s10, s10, 16
    s_mul_i32 s11, s11, 21846
    s_lshr_b32 s11, s11, 16
    v_cmp_le_u32 s[12:13], s10, v9
    v_cmp_ge_u32 vcc, s11, v9
    s_and_b32 s10, s12, vcc_lo
    s_or_b32 s11, s12, vcc_lo
    s_cmp_lt_u32 s7, s8
    s_cselect_b32 s10, s10, s11
    s_and_b32 s66, s10, s96
    s_mov_b32 s67, s97
    s_setprio 0
    v_bfe_u32 v9, v1, 1, 3
    v_xor_b32 v9, v9, v5
    v_lshlrev_b32 v10, 7, v4
    v_lshl_add_u32 v10, v9, 4, v10
    v_add_u32 v10, 28672, v10
    v_xor_b32 v11, 32, v10
    v_xor_b32 v12, 64, v10
    v_xor_b32 v13, 96, v10
    v_bfe_u32 v9, v1, 2, 2
    v_lshl_add_u32 v14, v5, 3, v9
    v_lshlrev_b32 v14, 8, v14
    v_and_b32 v6, 1, v1
    v_bfe_u32 v7, v1, 1, 1
    v_lshlrev_b32 v6, 4, v6
    v_lshl_add_u32 v6, v7, 3, v6
    v_bfe_u32 v7, v1, 4, 1
    v_lshl_add_u32 v6, v7, 5, v6
    s_lshl_b32 s7, s69, 6
    v_add_u32 v6, s7, v6
    v_lshlrev_b32 v9, 6, v9
    v_xor_b32 v6, v6, v9
    v_add_u32 v14, v14, v6
    v_add_u32 v14, 40960, v14
    v_mov_b32 v120, 0
    v_mov_b32 v121, 0
    v_mov_b32 v122, 0
    v_mov_b32 v123, 0
    v_mov_b32 v124, 0
    v_mov_b32 v125, 0
    v_mov_b32 v126, 0
    v_mov_b32 v127, 0
    v_mov_b32 v88, 0
    v_mov_b32 v89, 0
    v_mov_b32 v90, 0
    v_mov_b32 v91, 0
    v_mov_b32 v92, 0
    v_mov_b32 v93, 0
    v_mov_b32 v94, 0
    v_mov_b32 v95, 0
    v_mov_b32 v96, 0
    v_mov_b32 v97, 0
    v_mov_b32 v98, 0
    v_mov_b32 v99, 0
    v_mov_b32 v100, 0
    v_mov_b32 v101, 0
    v_mov_b32 v102, 0
    v_mov_b32 v103, 0
    v_mov_b32 v104, 0
    v_mov_b32 v105, 0
    v_mov_b32 v106, 0
    v_mov_b32 v107, 0
    v_mov_b32 v108, 0
    v_mov_b32 v109, 0
    v_mov_b32 v110, 0
    v_mov_b32 v111, 0
    v_mfma_f32_32x32x16_bf16 v[16:31], v[120:123], v[120:123], 0
    v_mfma_f32_32x32x16_bf16 v[32:47], v[120:123], v[120:123], 0
    v_mfma_f32_32x32x16_bf16 v[48:63], v[120:123], v[120:123], 0
    v_mfma_f32_32x32x16_bf16 a[0:15], v[120:123], v[120:123], 0
    v_mfma_f32_32x32x16_bf16 a[16:31], v[120:123], v[120:123], 0
    v_mfma_f32_32x32x16_bf16 a[32:47], v[120:123], v[120:123], 0
    v_mfma_f32_32x32x16_bf16 a[48:63], v[120:123], v[120:123], 0
    v_lshlrev_b32 v9, 2, v1
    v_mov_b32 v8, 0
    v_add_u32 v9, 148864, v9
    s_mov_b64 exec, 0xffff
    ds_write_b32 v9, v8
    s_mov_b64 exec, -1
    s_lshl_b32 s77, s5, 7
    s_lshl_b32 s7, s69, 5
    s_add_u32 s77, s77, s7
    s_mov_b32 s78, 0
    s_mov_b32 s79, 28672
    s_waitcnt lgkmcnt(0)
    s_lshr_b32 s7, s77, 5
    s_mul_i32 s14, s7, 22
    s_add_u32 s14, s14, s4
    s_lshl_b32 s14, s14, 7
    s_add_u32 s14, s14, 0xca1000
    s_mul_i32 s81, s4, 3
    s_cmp_lt_u32 s77, 448
    s_cselect_b32 s82, 17, 18
    s_cselect_b32 s83, 11, 12
    s_cselect_b32 s8, 0, 0x200000
    s_cselect_b32 s12, 0x3e8b97f6, 1.0
    s_cselect_b32 s86, 0, 0x3f803f80
    s_cselect_b32 s87, 0, 0x00003f80
    s_cselect_b32 s84, 0, 448
    s_cselect_b64 s[94:95], -1, 0
    s_mov_b32 s13, s12
    s_lshl_b32 s7, s81, s83
    s_add_u32 s8, s8, s7
    s_lshl_b32 s7, 1, s83
    s_add_u32 s9, s8, s7
    s_add_u32 s10, s9, s7
    s_lshl_b32 s11, 1, s82
    s_sub_u32 s11, s11, 1536
    s_add_u32 s82, s82, 1
    s_cmp_eq_u32 s4, 21
    s_cselect_b32 s9, 0x7fff0000, s9
    s_cselect_b32 s10, 0x7fff0000, s10
    s_cmp_ge_u32 s77, 1344
    s_cselect_b32 s6, 0, s6
    s_cmp_eq_u32 s6, 0
    s_cselect_b32 s8, 0x7fff0000, s8
    s_cselect_b32 s9, 0x7fff0000, s9
    s_cselect_b32 s10, 0x7fff0000, s10
    s_cselect_b32 s14, 0x7fff0000, s14
    v_mov_b32 v179, 0x7fff0000
    v_and_b32 v6, 4, v4
    v_and_b32 v7, 8, v4
    v_and_b32 v180, 0x13, v4
    v_lshl_or_b32 v180, v6, 1, v180
    v_lshrrev_b32 v7, 1, v7
    v_or_b32 v180, v180, v7
    s_cmp_ge_u32 s77, 896
    s_cbranch_scc1 L_MV_PRE
    v_cndmask_b32 v180, v180, v4, s[94:95]
    s_sub_u32 s84, s77, s84
    v_mov_b32 v178, v179
    v_lshl_add_u32 v6, v5, 3, s84
    v_add_u32 v6, 0, v6
    v_mul_u32_u24 v7, 1171, v6
    v_lshrrev_b32 v7, 16, v7
    v_mul_u32_u24 v181, 56, v7
    v_sub_u32 v6, v6, v181
    v_lshlrev_b32 v7, s82, v7
    v_lshl_add_u32 v7, v6, 6, v7
    v_lshl_add_u32 v7, v180, 4, v7
    v_cmp_lt_u32 vcc, 24, v6
    v_add_u32 v181, s11, v7
    v_cmp_eq_u32 s[92:93], 24, v6
    v_cndmask_b32 v7, v7, v181, vcc
    s_nop 0
    v_cndmask_b32 v176, v7, v179, s[92:93]
    v_cndmask_b32 v178, v178, v7, s[92:93]
    v_lshl_add_u32 v6, v5, 3, s84
    v_add_u32 v6, 16, v6
    v_mul_u32_u24 v7, 1171, v6
    v_lshrrev_b32 v7, 16, v7
    v_mul_u32_u24 v181, 56, v7
    v_sub_u32 v6, v6, v181
    v_lshlrev_b32 v7, s82, v7
    v_lshl_add_u32 v7, v6, 6, v7
    v_lshl_add_u32 v7, v180, 4, v7
    v_cmp_lt_u32 vcc, 24, v6
    v_add_u32 v181, s11, v7
    v_cmp_eq_u32 s[92:93], 24, v6
    v_cndmask_b32 v7, v7, v181, vcc
    s_nop 0
    v_cndmask_b32 v177, v7, v179, s[92:93]
    v_cndmask_b32 v178, v178, v7, s[92:93]
    v_cmp_ne_u32 vcc, v178, v179
    s_or_b32 s15, vcc_lo, vcc_hi
    v_mov_b32 v154, s86
    v_mov_b32 v155, s87
    v_mov_b32 v160, s86
    v_mov_b32 v161, s87
    v_mov_b32 v166, s86
    v_mov_b32 v167, s87
L_MQ_LOOP:
    s_barrier
    s_waitcnt lgkmcnt(5)
    v_mfma_f32_32x32x16_bf16 v[16:31], v[120:123], v[88:91], v[16:31]
    ds_read_b64_tr_b16 v[112:113], v14 offset:0
    ds_read_b64_tr_b16 v[114:115], v14 offset:1024
    v_mfma_f32_32x32x16_bf16 v[32:47], v[120:123], v[92:95], v[32:47]
    ds_read_b128 v[64:67], v10 offset:0
    ds_read_b128 v[68:71], v10 offset:4096
    v_mfma_f32_32x32x16_bf16 v[48:63], v[120:123], v[96:99], v[48:63]
    ds_read_b128 v[72:75], v10 offset:8192
    s_waitcnt lgkmcnt(5)
    v_mfma_f32_32x32x16_bf16 v[16:31], v[124:127], v[100:103], v[16:31]
    ds_read_b64_tr_b16 v[116:117], v14 offset:4096
    ds_read_b64_tr_b16 v[118:119], v14 offset:5120
    v_mfma_f32_32x32x16_bf16 v[32:47], v[124:127], v[104:107], v[32:47]
    ds_read_b128 v[76:79], v11 offset:0
    ds_read_b128 v[80:83], v11 offset:4096
    v_mfma_f32_32x32x16_bf16 v[48:63], v[124:127], v[108:111], v[48:63]
    ds_read_b128 v[84:87], v11 offset:8192
    s_add_u32 s79, s79, 28672
    s_cmp_eq_u32 s79, 114688
    s_mov_b32 s7, 28672
    s_cselect_b32 s7, 0xfffeb000, s7
    s_cselect_b32 s79, 0, s79
    s_waitcnt lgkmcnt(5)
    v_mfma_f32_32x32x16_bf16 v[16:31], v[112:115], v[64:67], v[16:31]
    ds_read_b64_tr_b16 v[120:121], v14 offset:8192
    ds_read_b64_tr_b16 v[122:123], v14 offset:9216
    v_mfma_f32_32x32x16_bf16 v[32:47], v[112:115], v[68:71], v[32:47]
    ds_read_b128 v[88:91], v12 offset:0
    ds_read_b128 v[92:95], v12 offset:4096
    v_mfma_f32_32x32x16_bf16 v[48:63], v[112:115], v[72:75], v[48:63]
    ds_read_b128 v[96:99], v12 offset:8192
    v_add_u32 v10, s7, v10
    v_add_u32 v11, s7, v11
    v_add_u32 v12, s7, v12
    s_waitcnt lgkmcnt(5)
    v_mfma_f32_32x32x16_bf16 v[16:31], v[116:119], v[76:79], v[16:31]
    ds_read_b64_tr_b16 v[124:125], v14 offset:12288
    ds_read_b64_tr_b16 v[126:127], v14 offset:13312
    v_mfma_f32_32x32x16_bf16 v[32:47], v[116:119], v[80:83], v[32:47]
    ds_read_b128 v[100:103], v13 offset:0
    ds_read_b128 v[104:107], v13 offset:4096
    v_mfma_f32_32x32x16_bf16 v[48:63], v[116:119], v[84:87], v[48:63]
    ds_read_b128 v[108:111], v13 offset:8192
    v_add_u32 v13, s7, v13
    v_add_u32 v14, s7, v14
    s_add_u32 s78, s78, 1
    s_cmp_lt_u32 s78, 7
    s_cbranch_scc1 L_MQ_LOOP
    v_mov_b32 v8, 148864
    ds_read_b32 v8, v8
    s_waitcnt lgkmcnt(0)
    s_barrier
    v_mfma_f32_32x32x16_bf16 v[16:31], v[120:123], v[88:91], v[16:31]
    v_mfma_f32_32x32x16_bf16 v[16:31], v[124:127], v[100:103], v[16:31]
    v_mfma_f32_32x32x16_bf16 v[32:47], v[120:123], v[92:95], v[32:47]
    v_mfma_f32_32x32x16_bf16 v[32:47], v[124:127], v[104:107], v[32:47]
    v_mfma_f32_32x32x16_bf16 v[48:63], v[120:123], v[96:99], v[48:63]
    v_mfma_f32_32x32x16_bf16 v[48:63], v[124:127], v[108:111], v[48:63]
    v_readfirstlane_b32 s68, v8
    s_nop 7
    v_pk_mul_f32 v[16:17], v[16:17], s[12:13]
    v_pk_mul_f32 v[18:19], v[18:19], s[12:13]
    v_pk_mul_f32 v[20:21], v[20:21], s[12:13]
    v_pk_mul_f32 v[22:23], v[22:23], s[12:13]
    v_cvt_pk_bf16_f32 v128, v16, v17
    v_cvt_pk_bf16_f32 v129, v18, v19
    v_cvt_pk_bf16_f32 v130, v20, v21
    v_cvt_pk_bf16_f32 v131, v22, v23
    buffer_store_dwordx4 v[128:131], v176, s[44:47], s8 offen sc1
    v_pk_mul_f32 v[24:25], v[24:25], s[12:13]
    v_pk_mul_f32 v[26:27], v[26:27], s[12:13]
    v_pk_mul_f32 v[28:29], v[28:29], s[12:13]
    v_pk_mul_f32 v[30:31], v[30:31], s[12:13]
    v_cvt_pk_bf16_f32 v132, v24, v25
    v_cvt_pk_bf16_f32 v133, v26, v27
    v_cvt_pk_bf16_f32 v134, v28, v29
    v_cvt_pk_bf16_f32 v135, v30, v31
    buffer_store_dwordx4 v[132:135], v177, s[44:47], s8 offen sc1
    v_pk_mul_f32 v[32:33], v[32:33], s[12:13]
    v_pk_mul_f32 v[34:35], v[34:35], s[12:13]
    v_pk_mul_f32 v[36:37], v[36:37], s[12:13]
    v_pk_mul_f32 v[38:39], v[38:39], s[12:13]
    v_cvt_pk_bf16_f32 v136, v32, v33
    v_cvt_pk_bf16_f32 v137, v34, v35
    v_cvt_pk_bf16_f32 v138, v36, v37
    v_cvt_pk_bf16_f32 v139, v38, v39
    buffer_store_dwordx4 v[136:139], v176, s[44:47], s9 offen sc1
    v_pk_mul_f32 v[40:41], v[40:41], s[12:13]
    v_pk_mul_f32 v[42:43], v[42:43], s[12:13]
    v_pk_mul_f32 v[44:45], v[44:45], s[12:13]
    v_pk_mul_f32 v[46:47], v[46:47], s[12:13]
    v_cvt_pk_bf16_f32 v140, v40, v41
    v_cvt_pk_bf16_f32 v141, v42, v43
    v_cvt_pk_bf16_f32 v142, v44, v45
    v_cvt_pk_bf16_f32 v143, v46, v47
    buffer_store_dwordx4 v[140:143], v177, s[44:47], s9 offen sc1
    v_pk_mul_f32 v[48:49], v[48:49], s[12:13]
    v_pk_mul_f32 v[50:51], v[50:51], s[12:13]
    v_pk_mul_f32 v[52:53], v[52:53], s[12:13]
    v_pk_mul_f32 v[54:55], v[54:55], s[12:13]
    v_cvt_pk_bf16_f32 v144, v48, v49
    v_cvt_pk_bf16_f32 v145, v50, v51
    v_cvt_pk_bf16_f32 v146, v52, v53
    v_cvt_pk_bf16_f32 v147, v54, v55
    buffer_store_dwordx4 v[144:147], v176, s[44:47], s10 offen sc1
    v_pk_mul_f32 v[56:57], v[56:57], s[12:13]
    v_pk_mul_f32 v[58:59], v[58:59], s[12:13]
    v_pk_mul_f32 v[60:61], v[60:61], s[12:13]
    v_pk_mul_f32 v[62:63], v[62:63], s[12:13]
    v_cvt_pk_bf16_f32 v148, v56, v57
    v_cvt_pk_bf16_f32 v149, v58, v59
    v_cvt_pk_bf16_f32 v150, v60, v61
    v_cvt_pk_bf16_f32 v151, v62, v63
    buffer_store_dwordx4 v[148:151], v177, s[44:47], s10 offen sc1
    s_cmp_eq_u32 s15, 0
    s_cbranch_scc1 L_M_ATT
    v_add_u32 v181, s11, v178
    v_cndmask_b32 v152, v128, v132, s[92:93]
    v_cndmask_b32 v153, v129, v133, s[92:93]
    v_cndmask_b32 v156, v130, v134, s[92:93]
    v_cndmask_b32 v157, v131, v135, s[92:93]
    buffer_store_dwordx4 v[152:155], v178, s[44:47], s8 offen sc1
    buffer_store_dwordx4 v[154:157], v181, s[44:47], s8 offen sc1
    v_cndmask_b32 v158, v136, v140, s[92:93]
    v_cndmask_b32 v159, v137, v141, s[92:93]
    v_cndmask_b32 v162, v138, v142, s[92:93]
    v_cndmask_b32 v163, v139, v143, s[92:93]
    buffer_store_dwordx4 v[158:161], v178, s[44:47], s9 offen sc1
    buffer_store_dwordx4 v[160:163], v181, s[44:47], s9 offen sc1
    v_cndmask_b32 v164, v144, v148, s[92:93]
    v_cndmask_b32 v165, v145, v149, s[92:93]
    v_cndmask_b32 v168, v146, v150, s[92:93]
    v_cndmask_b32 v169, v147, v151, s[92:93]
    buffer_store_dwordx4 v[164:167], v178, s[44:47], s10 offen sc1
    buffer_store_dwordx4 v[166:169], v181, s[44:47], s10 offen sc1
    s_branch L_M_ATT
L_MV_PRE:
    s_sub_u32 s84, s77, 896
    v_add_u32 v6, s84, v180
    v_mul_u32_u24 v7, 2341, v6
    v_lshrrev_b32 v7, 16, v7
    v_mul_u32_u24 v181, 28, v7
    v_sub_u32 v6, v6, v181
    v_lshl_add_u32 v6, v5, 5, v6
    v_lshlrev_b32 v6, 4, v6
    v_lshl_add_u32 v6, v7, 18, v6
    v_add_u32 v176, 2048, v6
    v_add_u32 v177, 3072, v6
L_MV_LOOP:
    s_barrier
    s_waitcnt lgkmcnt(5)
    v_mfma_f32_32x32x16_bf16 v[16:31], v[88:91], v[120:123], v[16:31]
    ds_read_b64_tr_b16 v[112:113], v14 offset:0
    ds_read_b64_tr_b16 v[114:115], v14 offset:1024
    v_mfma_f32_32x32x16_bf16 v[32:47], v[92:95], v[120:123], v[32:47]
    ds_read_b128 v[64:67], v10 offset:0
    ds_read_b128 v[68:71], v10 offset:4096
    v_mfma_f32_32x32x16_bf16 v[48:63], v[96:99], v[120:123], v[48:63]
    ds_read_b128 v[72:75], v10 offset:8192
    s_waitcnt lgkmcnt(5)
    v_mfma_f32_32x32x16_bf16 v[16:31], v[100:103], v[124:127], v[16:31]
    ds_read_b64_tr_b16 v[116:117], v14 offset:4096
    ds_read_b64_tr_b16 v[118:119], v14 offset:5120
    v_mfma_f32_32x32x16_bf16 v[32:47], v[104:107], v[124:127], v[32:47]
    ds_read_b128 v[76:79], v11 offset:0
    ds_read_b128 v[80:83], v11 offset:4096
    v_mfma_f32_32x32x16_bf16 v[48:63], v[108:111], v[124:127], v[48:63]
    ds_read_b128 v[84:87], v11 offset:8192
    s_add_u32 s79, s79, 28672
    s_cmp_eq_u32 s79, 114688
    s_mov_b32 s7, 28672
    s_cselect_b32 s7, 0xfffeb000, s7
    s_cselect_b32 s79, 0, s79
    s_waitcnt lgkmcnt(5)
    v_mfma_f32_32x32x16_bf16 v[16:31], v[64:67], v[112:115], v[16:31]
    ds_read_b64_tr_b16 v[120:121], v14 offset:8192
    ds_read_b64_tr_b16 v[122:123], v14 offset:9216
    v_mfma_f32_32x32x16_bf16 v[32:47], v[68:71], v[112:115], v[32:47]
    ds_read_b128 v[88:91], v12 offset:0
    ds_read_b128 v[92:95], v12 offset:4096
    v_mfma_f32_32x32x16_bf16 v[48:63], v[72:75], v[112:115], v[48:63]
    ds_read_b128 v[96:99], v12 offset:8192
    v_add_u32 v10, s7, v10
    v_add_u32 v11, s7, v11
    v_add_u32 v12, s7, v12
    s_waitcnt lgkmcnt(5)
    v_mfma_f32_32x32x16_bf16 v[16:31], v[76:79], v[116:119], v[16:31]
    ds_read_b64_tr_b16 v[124:125], v14 offset:12288
    ds_read_b64_tr_b16 v[126:127], v14 offset:13312
    v_mfma_f32_32x32x16_bf16 v[32:47], v[80:83], v[116:119], v[32:47]
    ds_read_b128 v[100:103], v13 offset:0
    ds_read_b128 v[104:107], v13 offset:4096
    v_mfma_f32_32x32x16_bf16 v[48:63], v[84:87], v[116:119], v[48:63]
    ds_read_b128 v[108:111], v13 offset:8192
    v_add_u32 v13, s7, v13
    v_add_u32 v14, s7, v14
    s_add_u32 s78, s78, 1
    s_cmp_lt_u32 s78, 7
    s_cbranch_scc1 L_MV_LOOP
    v_mov_b32 v8, 148864
    ds_read_b32 v8, v8
    s_waitcnt lgkmcnt(0)
    s_barrier
    v_mfma_f32_32x32x16_bf16 v[16:31], v[88:91], v[120:123], v[16:31]
    v_mfma_f32_32x32x16_bf16 v[16:31], v[100:103], v[124:127], v[16:31]
    v_mfma_f32_32x32x16_bf16 v[32:47], v[92:95], v[120:123], v[32:47]
    v_mfma_f32_32x32x16_bf16 v[32:47], v[104:107], v[124:127], v[32:47]
    v_mfma_f32_32x32x16_bf16 v[48:63], v[96:99], v[120:123], v[48:63]
    v_mfma_f32_32x32x16_bf16 v[48:63], v[108:111], v[124:127], v[48:63]
    v_readfirstlane_b32 s68, v8
    s_nop 7
    v_cvt_pk_bf16_f32 v128, v16, v17
    v_cvt_pk_bf16_f32 v129, v18, v19
    v_cvt_pk_bf16_f32 v130, v20, v21
    v_cvt_pk_bf16_f32 v131, v22, v23
    buffer_store_dwordx4 v[128:131], v176, s[44:47], s8 offen sc1
    v_cvt_pk_bf16_f32 v132, v24, v25
    v_cvt_pk_bf16_f32 v133, v26, v27
    v_cvt_pk_bf16_f32 v134, v28, v29
    v_cvt_pk_bf16_f32 v135, v30, v31
    buffer_store_dwordx4 v[132:135], v177, s[44:47], s8 offen sc1
    s_nop 1
    v_cvt_pk_bf16_f32 v136, v32, v33
    v_cvt_pk_bf16_f32 v137, v34, v35
    v_cvt_pk_bf16_f32 v138, v36, v37
    v_cvt_pk_bf16_f32 v139, v38, v39
    buffer_store_dwordx4 v[136:139], v176, s[44:47], s9 offen sc1
    v_cvt_pk_bf16_f32 v140, v40, v41
    v_cvt_pk_bf16_f32 v141, v42, v43
    v_cvt_pk_bf16_f32 v142, v44, v45
    v_cvt_pk_bf16_f32 v143, v46, v47
    buffer_store_dwordx4 v[140:143], v177, s[44:47], s9 offen sc1
    v_cvt_pk_bf16_f32 v144, v48, v49
    v_cvt_pk_bf16_f32 v145, v50, v51
    v_cvt_pk_bf16_f32 v146, v52, v53
    v_cvt_pk_bf16_f32 v147, v54, v55
    buffer_store_dwordx4 v[144:147], v176, s[44:47], s10 offen sc1
    v_cvt_pk_bf16_f32 v148, v56, v57
    v_cvt_pk_bf16_f32 v149, v58, v59
    v_cvt_pk_bf16_f32 v150, v60, v61
    v_cvt_pk_bf16_f32 v151, v62, v63
    buffer_store_dwordx4 v[148:151], v177, s[44:47], s10 offen sc1
L_M_ATT:
    s_mov_b32 s6, 0xffff
    v_mov_b32 v3, 0xdddd
    s_lshl_b32 s90, s70, 17
    s_lshl_b32 s7, s71, 13
    s_add_u32 s90, s90, s7
    s_lshl_b32 s91, s70, 18
    s_lshl_b32 s7, s69, 16
    s_add_u32 s91, s91, s7
    s_add_u32 s91, s91, 0x200000
    s_mov_b32 s88, 0x0fffffff
    s_mov_b32 s89, 0x0fffffff
    s_lshr_b32 s7, s71, 1
    s_mul_i32 s7, s7, 2
    s_and_b32 s7, s7, 15
    s_lshl_b32 s7, s7, 12
    s_add_u32 s72, s7, s91
    s_add_u32 s7, s7, 4096
    s_and_b32 s7, s7, 0xffff
    s_add_u32 s73, s7, s91
    s_add_u32 s7, s7, 4096
    s_and_b32 s7, s7, 0xffff
    s_add_u32 s74, s7, s91
    s_add_u32 s7, s7, 4096
    s_and_b32 s7, s7, 0xffff
    s_add_u32 s75, s7, s91
    s_add_u32 s7, s7, 4096
    s_and_b32 s7, s7, 0xffff
    s_add_u32 s76, s7, s91
    s_add_u32 s7, s7, 4096
    s_and_b32 s7, s7, 0xffff
    s_add_u32 s77, s7, s91
    s_add_u32 s7, s7, 4096
    s_and_b32 s7, s7, 0xffff
    s_add_u32 s78, s7, s91
    s_add_u32 s7, s7, 4096
    s_and_b32 s7, s7, 0xffff
    s_add_u32 s79, s7, s91
    s_add_u32 s7, s7, 4096
    s_and_b32 s7, s7, 0xffff
    s_add_u32 s80, s7, s91
    s_add_u32 s7, s7, 4096
    s_and_b32 s7, s7, 0xffff
    s_add_u32 s81, s7, s91
    s_add_u32 s7, s7, 4096
    s_and_b32 s7, s7, 0xffff
    s_add_u32 s82, s7, s91
    s_add_u32 s7, s7, 4096
    s_and_b32 s7, s7, 0xffff
    s_add_u32 s83, s7, s91
    s_add_u32 s7, s7, 4096
    s_and_b32 s7, s7, 0xffff
    s_add_u32 s84, s7, s91
    s_add_u32 s7, s7, 4096
    s_and_b32 s7, s7, 0xffff
    s_add_u32 s85, s7, s91
    s_add_u32 s7, s7, 4096
    s_and_b32 s7, s7, 0xffff
    s_add_u32 s86, s7, s91
    s_add_u32 s7, s7, 4096
    s_and_b32 s7, s7, 0xffff
    s_add_u32 s87, s7, s91
    s_add_u32 s7, s7, 4096
    s_and_b32 s7, s7, 0xffff
    s_add_u32 s7, s69, 1
    s_and_b32 s7, s7, 3
    s_lshl_b32 s7, s7, 11
    s_add_u32 s92, s7, s90
    s_add_u32 s7, s69, 2
    s_and_b32 s7, s7, 3
    s_lshl_b32 s7, s7, 11
    s_add_u32 s93, s7, s90
    s_add_u32 s7, s69, 3
    s_and_b32 s7, s7, 3
    s_lshl_b32 s7, s7, 11
    s_add_u32 s94, s7, s90
    s_add_u32 s7, s69, 4
    s_and_b32 s7, s7, 3
    s_lshl_b32 s7, s7, 11
    s_add_u32 s95, s7, s90
    v_cmp_eq_u32 vcc, 28, v4
    v_mov_b32 v13, 0x3f803f80
    s_nop 0
    v_cndmask_b32 v13, 0, v13, vcc
    v_mov_b32 v120, v13
    v_mov_b32 v121, v13
    v_mov_b32 v122, v13
    v_mov_b32 v123, v13
    v_mov_b32 v124, v13
    v_mov_b32 v125, v13
    v_mov_b32 v126, v13
    v_mov_b32 v127, v13
    v_mov_b32 v136, v13
    v_mov_b32 v137, v13
    v_mov_b32 v138, v13
    v_mov_b32 v139, v13
    v_mov_b32 v140, v13
    v_mov_b32 v141, v13
    v_mov_b32 v142, v13
    v_mov_b32 v143, v13
    v_mov_b32 v152, v13
    v_mov_b32 v153, v13
    v_mov_b32 v154, v13
    v_mov_b32 v155, v13
    v_mov_b32 v156, v13
    v_mov_b32 v157, v13
    v_mov_b32 v158, v13
    v_mov_b32 v159, v13
    v_mov_b32 v168, v13
    v_mov_b32 v169, v13
    v_mov_b32 v170, v13
    v_mov_b32 v171, v13
    v_mov_b32 v172, v13
    v_mov_b32 v173, v13
    v_mov_b32 v174, v13
    v_mov_b32 v175, v13
    s_mov_b32 s99, 0
    v_mov_b32 v8, s68
    v_mov_b32 v9, s68
    v_mov_b32 v10, s68
    v_mov_b32 v11, s68
    s_waitcnt vmcnt(0)
    s_mov_b64 exec, 0xff
    buffer_store_dwordx4 v[8:11], v2, s[44:47], s14 offen sc1
    s_mov_b64 exec, -1
    s_waitcnt vmcnt(0)
    s_mov_b32 s98, 131072
    s_mov_b64 exec, s[66:67]
POLL_27:
    buffer_load_dword v7, v182, s[44:47], 0 offen sc1
    s_waitcnt vmcnt(0)
    v_cmp_ne_u32 vcc, s68, v7
    s_cbranch_vccnz RETRY_28
    s_mov_b64 exec, -1
L_RESTART:
    buffer_load_dwordx4 v[16:19], v2, s[44:47], s92 offen offset:0 sc1
    buffer_load_dwordx4 v[20:23], v2, s[44:47], s92 offen offset:1024 sc1
    buffer_load_dwordx4 v[112:115], v2, s[44:47], s72 offen offset:0 sc1
    buffer_load_dwordx4 v[116:119], v2, s[44:47], s72 offen offset:1024 sc1
    buffer_load_dwordx4 v[24:27], v2, s[44:47], s93 offen offset:0 sc1
    buffer_load_dwordx4 v[28:31], v2, s[44:47], s93 offen offset:1024 sc1
    s_mov_b64 exec, s[88:89]
    buffer_load_dwordx4 v[120:123], v2, s[44:47], s72 offen offset:2048 sc1
    buffer_load_dwordx4 v[124:127], v2, s[44:47], s72 offen offset:3072 sc1
    s_mov_b64 exec, -1
    buffer_load_dwordx4 v[32:35], v2, s[44:47], s94 offen offset:0 sc1
    buffer_load_dwordx4 v[36:39], v2, s[44:47], s94 offen offset:1024 sc1
    buffer_load_dwordx4 v[40:43], v2, s[44:47], s95 offen offset:0 sc1
    buffer_load_dwordx4 v[44:47], v2, s[44:47], s95 offen offset:1024 sc1
    s_add_u32 s7, s69, 1
    s_and_b32 s7, s7, 3
    s_mul_i32 s7, s7, 12288
    s_add_u32 s7, s7, 74880
    v_add_u32 v6, s7, v2
    s_add_u32 s7, s69, 2
    s_and_b32 s7, s7, 3
    s_mul_i32 s7, s7, 12288
    s_add_u32 s7, s7, 78976
    v_add_u32 v7, s7, v2
    s_add_u32 s7, s69, 3
    s_and_b32 s7, s7, 3
    s_mul_i32 s7, s7, 12288
    s_add_u32 s7, s7, 83072
    v_add_u32 v8, s7, v2
    v_mov_b32 v9, 148864
    v_mov_b32 v10, 1
    s_setprio 2
    s_waitcnt vmcnt(8)
    v_mfma_f32_32x32x16_bf16 v[48:63], v[112:115], v[16:19], 0
    v_mfma_f32_32x32x16_bf16 v[48:63], v[116:119], v[20:23], v[48:63]
    buffer_load_dwordx4 v[128:131], v2, s[44:47], s73 offen offset:0 sc1
    buffer_load_dwordx4 v[132:135], v2, s[44:47], s73 offen offset:1024 sc1
    s_mov_b64 exec, s[88:89]
    buffer_load_dwordx4 v[136:139], v2, s[44:47], s73 offen offset:2048 sc1
    buffer_load_dwordx4 v[140:143], v2, s[44:47], s73 offen offset:3072 sc1
    s_mov_b64 exec, -1
    s_nop 5
    s_waitcnt vmcnt(10)
    v_mfma_f32_32x32x16_bf16 v[64:79], v[112:115], v[24:27], 0
    v_exp_f32 v48, v48
    v_exp_f32 v49, v49
    v_exp_f32 v50, v50
    v_exp_f32 v51, v51
    v_mfma_f32_32x32x16_bf16 v[64:79], v[116:119], v[28:31], v[64:79]
    v_exp_f32 v52, v52
    v_exp_f32 v53, v53
    buffer_load_dwordx4 v[144:147], v2, s[44:47], s74 offen offset:0 sc1
    buffer_load_dwordx4 v[148:151], v2, s[44:47], s74 offen offset:1024 sc1
    v_exp_f32 v54, v54
    v_exp_f32 v55, v55
    v_exp_f32 v56, v56
    v_exp_f32 v57, v57
    v_exp_f32 v58, v58
    v_exp_f32 v59, v59
    s_waitcnt vmcnt(10)
    v_smfmac_f32_32x32x32_bf16 a[0:15], v[120:123], v[48:55], v3
    v_exp_f32 v60, v60
    v_exp_f32 v61, v61
    v_exp_f32 v62, v62
    v_exp_f32 v63, v63
    s_waitcnt vmcnt(8)
    v_mfma_f32_32x32x16_bf16 v[80:95], v[112:115], v[32:35], 0
    v_exp_f32 v64, v64
    v_exp_f32 v65, v65
    v_exp_f32 v66, v66
    v_exp_f32 v67, v67
    v_mfma_f32_32x32x16_bf16 v[80:95], v[116:119], v[36:39], v[80:95]
    v_exp_f32 v68, v68
    v_exp_f32 v69, v69
    v_exp_f32 v70, v70
    v_exp_f32 v71, v71
    v_smfmac_f32_32x32x32_bf16 a[0:15], v[124:127], v[56:63], v3
    v_exp_f32 v72, v72
    v_exp_f32 v73, v73
    s_mov_b64 exec, s[88:89]
    buffer_load_dwordx4 v[152:155], v2, s[44:47], s74 offen offset:2048 sc1
    buffer_load_dwordx4 v[156:159], v2, s[44:47], s74 offen offset:3072 sc1
    s_mov_b64 exec, -1
    v_exp_f32 v74, v74
    v_exp_f32 v75, v75
    v_smfmac_f32_32x32x32_bf16 a[16:31], v[120:123], v[64:71], v3
    v_exp_f32 v76, v76
    v_exp_f32 v77, v77
    v_exp_f32 v78, v78
    v_exp_f32 v79, v79
    s_waitcnt vmcnt(8)
    v_mfma_f32_32x32x16_bf16 v[96:111], v[112:115], v[40:43], 0
    v_exp_f32 v80, v80
    v_exp_f32 v81, v81
    v_exp_f32 v82, v82
    v_exp_f32 v83, v83
    v_mfma_f32_32x32x16_bf16 v[96:111], v[116:119], v[44:47], v[96:111]
    v_exp_f32 v84, v84
    v_exp_f32 v85, v85
    buffer_load_dwordx4 v[160:163], v2, s[44:47], s75 offen offset:0 sc1
    buffer_load_dwordx4 v[164:167], v2, s[44:47], s75 offen offset:1024 sc1
    v_exp_f32 v86, v86
    v_exp_f32 v87, v87
    v_smfmac_f32_32x32x32_bf16 a[16:31], v[124:127], v[72:79], v3
    v_exp_f32 v88, v88
    v_exp_f32 v89, v89
    v_exp_f32 v90, v90
    s_mov_b64 exec, s[96:97]
    buffer_load_dword v183, v182, s[44:47], 0 offen sc1
    s_mov_b64 exec, -1
    v_exp_f32 v91, v91
    v_smfmac_f32_32x32x32_bf16 a[32:47], v[120:123], v[80:87], v3
    v_exp_f32 v92, v92
    v_exp_f32 v93, v93
    v_exp_f32 v94, v94
    v_exp_f32 v95, v95
    s_waitcnt vmcnt(9)
    v_mfma_f32_32x32x16_bf16 v[48:63], v[128:131], v[16:19], 0
    v_exp_f32 v96, v96
    v_exp_f32 v97, v97
    v_exp_f32 v98, v98
    v_exp_f32 v99, v99
    v_mfma_f32_32x32x16_bf16 v[48:63], v[132:135], v[20:23], v[48:63]
    v_exp_f32 v100, v100
    v_exp_f32 v101, v101
    v_exp_f32 v102, v102
    v_exp_f32 v103, v103
    v_smfmac_f32_32x32x32_bf16 a[32:47], v[124:127], v[88:95], v3
    v_exp_f32 v104, v104
    v_exp_f32 v105, v105
    s_mov_b64 exec, s[88:89]
    buffer_load_dwordx4 v[168:171], v2, s[44:47], s75 offen offset:2048 sc1
    buffer_load_dwordx4 v[172:175], v2, s[44:47], s75 offen offset:3072 sc1
    s_mov_b64 exec, -1
    v_exp_f32 v106, v106
    v_exp_f32 v107, v107
    v_smfmac_f32_32x32x32_bf16 a[48:63], v[120:123], v[96:103], v3
    v_exp_f32 v108, v108
    v_exp_f32 v109, v109
    v_exp_f32 v110, v110
    s_mov_b64 exec, 1
    ds_write_b32 v9, v10 offset:4
    s_mov_b64 exec, -1
    v_exp_f32 v111, v111
    v_mfma_f32_32x32x16_bf16 v[64:79], v[128:131], v[24:27], 0
    v_exp_f32 v48, v48
    v_exp_f32 v49, v49
    v_exp_f32 v50, v50
    v_exp_f32 v51, v51
    v_mfma_f32_32x32x16_bf16 v[64:79], v[132:135], v[28:31], v[64:79]
    v_exp_f32 v52, v52
    v_exp_f32 v53, v53
    v_exp_f32 v54, v54
    v_exp_f32 v55, v55
    v_smfmac_f32_32x32x32_bf16 a[48:63], v[124:127], v[104:111], v3
    v_exp_f32 v56, v56
    v_exp_f32 v57, v57
    v_exp_f32 v58, v58
    v_exp_f32 v59, v59
    s_waitcnt vmcnt(9)
    v_smfmac_f32_32x32x32_bf16 a[0:15], v[136:139], v[48:55], v3
    v_exp_f32 v60, v60
    v_exp_f32 v61, v61
    v_exp_f32 v62, v62
    v_exp_f32 v63, v63
    v_mfma_f32_32x32x16_bf16 v[80:95], v[128:131], v[32:35], 0
    v_exp_f32 v64, v64
    v_exp_f32 v65, v65
    v_exp_f32 v66, v66
    s_waitcnt vmcnt(2)
    v_cmp_ne_u32 vcc, s68, v183
    s_and_b64 vcc, vcc, s[96:97]
    s_cbranch_scc1 L_LATE
L_LATE_BACK:
    v_exp_f32 v67, v67
    v_mfma_f32_32x32x16_bf16 v[80:95], v[132:135], v[36:39], v[80:95]
    v_exp_f32 v68, v68
    v_exp_f32 v69, v69
    buffer_load_dwordx4 v[112:115], v2, s[44:47], s76 offen offset:0 sc1
    buffer_load_dwordx4 v[116:119], v2, s[44:47], s76 offen offset:1024 sc1
    v_exp_f32 v70, v70
    v_exp_f32 v71, v71
    v_smfmac_f32_32x32x32_bf16 a[0:15], v[140:143], v[56:63], v3
    v_exp_f32 v72, v72
    v_exp_f32 v73, v73
    s_mov_b64 exec, s[88:89]
    buffer_load_dwordx4 v[120:123], v2, s[44:47], s76 offen offset:2048 sc1
    buffer_load_dwordx4 v[124:127], v2, s[44:47], s76 offen offset:3072 sc1
    s_mov_b64 exec, -1
    v_exp_f32 v74, v74
    v_exp_f32 v75, v75
    v_smfmac_f32_32x32x32_bf16 a[16:31], v[136:139], v[64:71], v3
    v_exp_f32 v76, v76
    v_exp_f32 v77, v77
    v_exp_f32 v78, v78
    v_exp_f32 v79, v79
    v_mfma_f32_32x32x16_bf16 v[96:111], v[128:131], v[40:43], 0
    v_exp_f32 v80, v80
    v_exp_f32 v81, v81
    v_exp_f32 v82, v82
    v_exp_f32 v83, v83
    v_mfma_f32_32x32x16_bf16 v[96:111], v[132:135], v[44:47], v[96:111]
    v_exp_f32 v84, v84
    v_exp_f32 v85, v85
    buffer_load_dwordx4 v[128:131], v2, s[44:47], s77 offen offset:0 sc1
    buffer_load_dwordx4 v[132:135], v2, s[44:47], s77 offen offset:1024 sc1
    v_exp_f32 v86, v86
    v_exp_f32 v87, v87
    v_smfmac_f32_32x32x32_bf16 a[16:31], v[140:143], v[72:79], v3
    v_exp_f32 v88, v88
    v_exp_f32 v89, v89
    v_exp_f32 v90, v90
    v_exp_f32 v91, v91
    v_smfmac_f32_32x32x32_bf16 a[32:47], v[136:139], v[80:87], v3
    v_exp_f32 v92, v92
    v_exp_f32 v93, v93
    v_exp_f32 v94, v94
    v_exp_f32 v95, v95
    v_mfma_f32_32x32x16_bf16 v[48:63], v[144:147], v[16:19], 0
    v_exp_f32 v96, v96
    v_exp_f32 v97, v97
    v_exp_f32 v98, v98
    v_exp_f32 v99, v99
    v_mfma_f32_32x32x16_bf16 v[48:63], v[148:151], v[20:23], v[48:63]
    v_exp_f32 v100, v100
    v_exp_f32 v101, v101
    v_exp_f32 v102, v102
    v_exp_f32 v103, v103
    v_smfmac_f32_32x32x32_bf16 a[32:47], v[140:143], v[88:95], v3
    v_exp_f32 v104, v104
    v_exp_f32 v105, v105
    v_exp_f32 v106, v106
    v_exp_f32 v107, v107
    v_smfmac_f32_32x32x32_bf16 a[48:63], v[136:139], v[96:103], v3
    v_exp_f32 v108, v108
    v_exp_f32 v109, v109
    v_exp_f32 v110, v110
    v_exp_f32 v111, v111
    v_mfma_f32_32x32x16_bf16 v[64:79], v[144:147], v[24:27], 0
    v_exp_f32 v48, v48
    v_exp_f32 v49, v49
    v_exp_f32 v50, v50
    v_exp_f32 v51, v51
    v_mfma_f32_32x32x16_bf16 v[64:79], v[148:151], v[28:31], v[64:79]
    v_exp_f32 v52, v52
    v_exp_f32 v53, v53
    v_exp_f32 v54, v54
    v_exp_f32 v55, v55
    v_smfmac_f32_32x32x32_bf16 a[48:63], v[140:143], v[104:111], v3
    v_exp_f32 v56, v56
    v_exp_f32 v57, v57
    s_mov_b64 exec, s[88:89]
    buffer_load_dwordx4 v[136:139], v2, s[44:47], s77 offen offset:2048 sc1
    buffer_load_dwordx4 v[140:143], v2, s[44:47], s77 offen offset:3072 sc1
    s_mov_b64 exec, -1
    v_exp_f32 v58, v58
    v_exp_f32 v59, v59
    v_smfmac_f32_32x32x32_bf16 a[0:15], v[152:155], v[48:55], v3
    v_exp_f32 v60, v60
    v_exp_f32 v61, v61
    v_exp_f32 v62, v62
    v_exp_f32 v63, v63
    v_mfma_f32_32x32x16_bf16 v[80:95], v[144:147], v[32:35], 0
    v_exp_f32 v64, v64
    v_exp_f32 v65, v65
    v_exp_f32 v66, v66
    v_exp_f32 v67, v67
    v_mfma_f32_32x32x16_bf16 v[80:95], v[148:151], v[36:39], v[80:95]
    v_exp_f32 v68, v68
    v_exp_f32 v69, v69
    v_exp_f32 v70, v70
    v_exp_f32 v71, v71
    v_smfmac_f32_32x32x32_bf16 a[0:15], v[156:159], v[56:63], v3
    v_exp_f32 v72, v72
    v_exp_f32 v73, v73
    v_exp_f32 v74, v74
    v_exp_f32 v75, v75
    v_smfmac_f32_32x32x32_bf16 a[16:31], v[152:155], v[64:71], v3
    v_exp_f32 v76, v76
    v_exp_f32 v77, v77
    v_exp_f32 v78, v78
    v_exp_f32 v79, v79
    v_mfma_f32_32x32x16_bf16 v[96:111], v[144:147], v[40:43], 0
    v_exp_f32 v80, v80
    v_exp_f32 v81, v81
    v_exp_f32 v82, v82
    v_exp_f32 v83, v83
    v_mfma_f32_32x32x16_bf16 v[96:111], v[148:151], v[44:47], v[96:111]
    v_exp_f32 v84, v84
    v_exp_f32 v85, v85
    buffer_load_dwordx4 v[144:147], v2, s[44:47], s78 offen offset:0 sc1
    buffer_load_dwordx4 v[148:151], v2, s[44:47], s78 offen offset:1024 sc1
    v_exp_f32 v86, v86
    v_exp_f32 v87, v87
    v_smfmac_f32_32x32x32_bf16 a[16:31], v[156:159], v[72:79], v3
    v_exp_f32 v88, v88
    v_exp_f32 v89, v89
    v_exp_f32 v90, v90
    v_exp_f32 v91, v91
    v_smfmac_f32_32x32x32_bf16 a[32:47], v[152:155], v[80:87], v3
    v_exp_f32 v92, v92
    v_exp_f32 v93, v93
    v_exp_f32 v94, v94
    v_exp_f32 v95, v95
    v_mfma_f32_32x32x16_bf16 v[48:63], v[160:163], v[16:19], 0
    v_exp_f32 v96, v96
    v_exp_f32 v97, v97
    v_exp_f32 v98, v98
    v_exp_f32 v99, v99
    v_mfma_f32_32x32x16_bf16 v[48:63], v[164:167], v[20:23], v[48:63]
    v_exp_f32 v100, v100
    v_exp_f32 v101, v101
    v_exp_f32 v102, v102
    v_exp_f32 v103, v103
    v_smfmac_f32_32x32x32_bf16 a[32:47], v[156:159], v[88:95], v3
    v_exp_f32 v104, v104
    v_exp_f32 v105, v105
    v_exp_f32 v106, v106
    v_exp_f32 v107, v107
    v_smfmac_f32_32x32x32_bf16 a[48:63], v[152:155], v[96:103], v3
    v_exp_f32 v108, v108
    v_exp_f32 v109, v109
    v_exp_f32 v110, v110
    v_exp_f32 v111, v111
    v_mfma_f32_32x32x16_bf16 v[64:79], v[160:163], v[24:27], 0
    v_exp_f32 v48, v48
    v_exp_f32 v49, v49
    v_exp_f32 v50, v50
    v_exp_f32 v51, v51
    v_mfma_f32_32x32x16_bf16 v[64:79], v[164:167], v[28:31], v[64:79]
    v_exp_f32 v52, v52
    v_exp_f32 v53, v53
    v_exp_f32 v54, v54
    v_exp_f32 v55, v55
    v_smfmac_f32_32x32x32_bf16 a[48:63], v[156:159], v[104:111], v3
    v_exp_f32 v56, v56
    v_exp_f32 v57, v57
    s_mov_b64 exec, s[88:89]
    buffer_load_dwordx4 v[152:155], v2, s[44:47], s78 offen offset:2048 sc1
    buffer_load_dwordx4 v[156:159], v2, s[44:47], s78 offen offset:3072 sc1
    s_mov_b64 exec, -1
    v_exp_f32 v58, v58
    v_exp_f32 v59, v59
    s_waitcnt vmcnt(12)
    v_smfmac_f32_32x32x32_bf16 a[0:15], v[168:171], v[48:55], v3
    v_exp_f32 v60, v60
    v_exp_f32 v61, v61
    v_exp_f32 v62, v62
    v_exp_f32 v63, v63
    v_mfma_f32_32x32x16_bf16 v[80:95], v[160:163], v[32:35], 0
    v_exp_f32 v64, v64
    v_exp_f32 v65, v65
    v_exp_f32 v66, v66
    v_exp_f32 v67, v67
    v_mfma_f32_32x32x16_bf16 v[80:95], v[164:167], v[36:39], v[80:95]
    v_exp_f32 v68, v68
    v_exp_f32 v69, v69
    v_exp_f32 v70, v70
    v_exp_f32 v71, v71
    v_smfmac_f32_32x32x32_bf16 a[0:15], v[172:175], v[56:63], v3
    v_exp_f32 v72, v72
    v_exp_f32 v73, v73
    v_exp_f32 v74, v74
    v_exp_f32 v75, v75
    v_smfmac_f32_32x32x32_bf16 a[16:31], v[168:171], v[64:71], v3
    v_exp_f32 v76, v76
    v_exp_f32 v77, v77
    v_exp_f32 v78, v78
    v_exp_f32 v79, v79
    v_mfma_f32_32x32x16_bf16 v[96:111], v[160:163], v[40:43], 0
    v_exp_f32 v80, v80
    v_exp_f32 v81, v81
    v_exp_f32 v82, v82
    v_exp_f32 v83, v83
    v_mfma_f32_32x32x16_bf16 v[96:111], v[164:167], v[44:47], v[96:111]
    v_exp_f32 v84, v84
    v_exp_f32 v85, v85
    buffer_load_dwordx4 v[160:163], v2, s[44:47], s79 offen offset:0 sc1
    buffer_load_dwordx4 v[164:167], v2, s[44:47], s79 offen offset:1024 sc1
    v_exp_f32 v86, v86
    v_exp_f32 v87, v87
    v_smfmac_f32_32x32x32_bf16 a[16:31], v[172:175], v[72:79], v3
    v_exp_f32 v88, v88
    v_exp_f32 v89, v89
    v_exp_f32 v90, v90
    v_exp_f32 v91, v91
    v_smfmac_f32_32x32x32_bf16 a[32:47], v[168:171], v[80:87], v3
    v_exp_f32 v92, v92
    v_exp_f32 v93, v93
    v_exp_f32 v94, v94
    v_exp_f32 v95, v95
    s_waitcnt vmcnt(12)
    v_mfma_f32_32x32x16_bf16 v[48:63], v[112:115], v[16:19], 0
    v_exp_f32 v96, v96
    v_exp_f32 v97, v97
    v_exp_f32 v98, v98
    v_exp_f32 v99, v99
    v_mfma_f32_32x32x16_bf16 v[48:63], v[116:119], v[20:23], v[48:63]
    v_exp_f32 v100, v100
    v_exp_f32 v101, v101
    v_exp_f32 v102, v102
    v_exp_f32 v103, v103
    v_smfmac_f32_32x32x32_bf16 a[32:47], v[172:175], v[88:95], v3
    v_exp_f32 v104, v104
    v_exp_f32 v105, v105
    v_exp_f32 v106, v106
    v_exp_f32 v107, v107
    v_smfmac_f32_32x32x32_bf16 a[48:63], v[168:171], v[96:103], v3
    v_exp_f32 v108, v108
    v_exp_f32 v109, v109
    v_exp_f32 v110, v110
    v_exp_f32 v111, v111
    v_mfma_f32_32x32x16_bf16 v[64:79], v[112:115], v[24:27], 0
    v_exp_f32 v48, v48
    v_exp_f32 v49, v49
    v_exp_f32 v50, v50
    v_exp_f32 v51, v51
    v_mfma_f32_32x32x16_bf16 v[64:79], v[116:119], v[28:31], v[64:79]
    v_exp_f32 v52, v52
    v_exp_f32 v53, v53
    v_exp_f32 v54, v54
    v_exp_f32 v55, v55
    v_smfmac_f32_32x32x32_bf16 a[48:63], v[172:175], v[104:111], v3
    v_exp_f32 v56, v56
    v_exp_f32 v57, v57
    s_mov_b64 exec, s[88:89]
    buffer_load_dwordx4 v[168:171], v2, s[44:47], s79 offen offset:2048 sc1
    buffer_load_dwordx4 v[172:175], v2, s[44:47], s79 offen offset:3072 sc1
    s_mov_b64 exec, -1
    v_exp_f32 v58, v58
    v_exp_f32 v59, v59
    s_waitcnt vmcnt(12)
    v_smfmac_f32_32x32x32_bf16 a[0:15], v[120:123], v[48:55], v3
    v_exp_f32 v60, v60
    v_exp_f32 v61, v61
    v_exp_f32 v62, v62
    v_exp_f32 v63, v63
    v_mfma_f32_32x32x16_bf16 v[80:95], v[112:115], v[32:35], 0
    v_exp_f32 v64, v64
    v_exp_f32 v65, v65
    v_exp_f32 v66, v66
    v_exp_f32 v67, v67
    v_mfma_f32_32x32x16_bf16 v[80:95], v[116:119], v[36:39], v[80:95]
    v_exp_f32 v68, v68
    v_exp_f32 v69, v69
    v_exp_f32 v70, v70
    v_exp_f32 v71, v71
    v_smfmac_f32_32x32x32_bf16 a[0:15], v[124:127], v[56:63], v3
    v_exp_f32 v72, v72
    v_exp_f32 v73, v73
    v_exp_f32 v74, v74
    v_exp_f32 v75, v75
    v_smfmac_f32_32x32x32_bf16 a[16:31], v[120:123], v[64:71], v3
    v_exp_f32 v76, v76
    v_exp_f32 v77, v77
    v_exp_f32 v78, v78
    v_exp_f32 v79, v79
    v_mfma_f32_32x32x16_bf16 v[96:111], v[112:115], v[40:43], 0
    v_exp_f32 v80, v80
    v_exp_f32 v81, v81
    v_exp_f32 v82, v82
    v_exp_f32 v83, v83
    v_mfma_f32_32x32x16_bf16 v[96:111], v[116:119], v[44:47], v[96:111]
    v_exp_f32 v84, v84
    v_exp_f32 v85, v85
    buffer_load_dwordx4 v[112:115], v2, s[44:47], s80 offen offset:0 sc1
    buffer_load_dwordx4 v[116:119], v2, s[44:47], s80 offen offset:1024 sc1
    v_exp_f32 v86, v86
    v_exp_f32 v87, v87
    v_smfmac_f32_32x32x32_bf16 a[16:31], v[124:127], v[72:79], v3
    v_exp_f32 v88, v88
    v_exp_f32 v89, v89
    v_exp_f32 v90, v90
    v_exp_f32 v91, v91
    v_smfmac_f32_32x32x32_bf16 a[32:47], v[120:123], v[80:87], v3
    v_exp_f32 v92, v92
    v_exp_f32 v93, v93
    v_exp_f32 v94, v94
    v_exp_f32 v95, v95
    s_waitcnt vmcnt(12)
    v_mfma_f32_32x32x16_bf16 v[48:63], v[128:131], v[16:19], 0
    v_exp_f32 v96, v96
    v_exp_f32 v97, v97
    v_exp_f32 v98, v98
    v_exp_f32 v99, v99
    v_mfma_f32_32x32x16_bf16 v[48:63], v[132:135], v[20:23], v[48:63]
    v_exp_f32 v100, v100
    v_exp_f32 v101, v101
    v_exp_f32 v102, v102
    v_exp_f32 v103, v103
    v_smfmac_f32_32x32x32_bf16 a[32:47], v[124:127], v[88:95], v3
    v_exp_f32 v104, v104
    v_exp_f32 v105, v105
    v_exp_f32 v106, v106
    v_exp_f32 v107, v107
    v_smfmac_f32_32x32x32_bf16 a[48:63], v[120:123], v[96:103], v3
    v_exp_f32 v108, v108
    v_exp_f32 v109, v109
    v_exp_f32 v110, v110
    v_exp_f32 v111, v111
    v_mfma_f32_32x32x16_bf16 v[64:79], v[128:131], v[24:27], 0
    v_exp_f32 v48, v48
    v_exp_f32 v49, v49
    v_exp_f32 v50, v50
    v_exp_f32 v51, v51
    v_mfma_f32_32x32x16_bf16 v[64:79], v[132:135], v[28:31], v[64:79]
    v_exp_f32 v52, v52
    v_exp_f32 v53, v53
    v_exp_f32 v54, v54
    v_exp_f32 v55, v55
    v_smfmac_f32_32x32x32_bf16 a[48:63], v[124:127], v[104:111], v3
    v_exp_f32 v56, v56
    v_exp_f32 v57, v57
    s_mov_b64 exec, s[88:89]
    buffer_load_dwordx4 v[120:123], v2, s[44:47], s80 offen offset:2048 sc1
    buffer_load_dwordx4 v[124:127], v2, s[44:47], s80 offen offset:3072 sc1
    s_mov_b64 exec, -1
    v_exp_f32 v58, v58
    v_exp_f32 v59, v59
    s_waitcnt vmcnt(12)
    v_smfmac_f32_32x32x32_bf16 a[0:15], v[136:139], v[48:55], v3
    v_exp_f32 v60, v60
    v_exp_f32 v61, v61
    v_exp_f32 v62, v62
    v_exp_f32 v63, v63
    v_mfma_f32_32x32x16_bf16 v[80:95], v[128:131], v[32:35], 0
    v_exp_f32 v64, v64
    v_exp_f32 v65, v65
    v_exp_f32 v66, v66
    v_exp_f32 v67, v67
    v_mfma_f32_32x32x16_bf16 v[80:95], v[132:135], v[36:39], v[80:95]
    v_exp_f32 v68, v68
    v_exp_f32 v69, v69
    v_exp_f32 v70, v70
    v_exp_f32 v71, v71
    v_smfmac_f32_32x32x32_bf16 a[0:15], v[140:143], v[56:63], v3
    v_exp_f32 v72, v72
    v_exp_f32 v73, v73
    v_exp_f32 v74, v74
    v_exp_f32 v75, v75
    v_smfmac_f32_32x32x32_bf16 a[16:31], v[136:139], v[64:71], v3
    v_exp_f32 v76, v76
    v_exp_f32 v77, v77
    v_exp_f32 v78, v78
    v_exp_f32 v79, v79
    v_mfma_f32_32x32x16_bf16 v[96:111], v[128:131], v[40:43], 0
    v_exp_f32 v80, v80
    v_exp_f32 v81, v81
    v_exp_f32 v82, v82
    v_exp_f32 v83, v83
    v_mfma_f32_32x32x16_bf16 v[96:111], v[132:135], v[44:47], v[96:111]
    v_exp_f32 v84, v84
    v_exp_f32 v85, v85
    buffer_load_dwordx4 v[128:131], v2, s[44:47], s81 offen offset:0 sc1
    buffer_load_dwordx4 v[132:135], v2, s[44:47], s81 offen offset:1024 sc1
    v_exp_f32 v86, v86
    v_exp_f32 v87, v87
    v_smfmac_f32_32x32x32_bf16 a[16:31], v[140:143], v[72:79], v3
    v_exp_f32 v88, v88
    v_exp_f32 v89, v89
    v_exp_f32 v90, v90
    v_exp_f32 v91, v91
    v_smfmac_f32_32x32x32_bf16 a[32:47], v[136:139], v[80:87], v3
    v_exp_f32 v92, v92
    v_exp_f32 v93, v93
    v_exp_f32 v94, v94
    v_exp_f32 v95, v95
    s_waitcnt vmcnt(10)
    v_mfma_f32_32x32x16_bf16 v[48:63], v[144:147], v[16:19], 0
    v_exp_f32 v96, v96
    v_exp_f32 v97, v97
    v_exp_f32 v98, v98
    v_exp_f32 v99, v99
    v_mfma_f32_32x32x16_bf16 v[48:63], v[148:151], v[20:23], v[48:63]
    v_exp_f32 v100, v100
    v_exp_f32 v101, v101
    v_exp_f32 v102, v102
    v_exp_f32 v103, v103
    v_smfmac_f32_32x32x32_bf16 a[32:47], v[140:143], v[88:95], v3
    v_exp_f32 v104, v104
    v_exp_f32 v105, v105
    v_exp_f32 v106, v106
    v_exp_f32 v107, v107
    v_smfmac_f32_32x32x32_bf16 a[48:63], v[136:139], v[96:103], v3
    v_exp_f32 v108, v108
    v_exp_f32 v109, v109
    v_exp_f32 v110, v110
    v_exp_f32 v111, v111
    v_mfma_f32_32x32x16_bf16 v[64:79], v[144:147], v[24:27], 0
    v_exp_f32 v48, v48
    v_exp_f32 v49, v49
    v_exp_f32 v50, v50
    v_exp_f32 v51, v51
    v_mfma_f32_32x32x16_bf16 v[64:79], v[148:151], v[28:31], v[64:79]
    v_exp_f32 v52, v52
    v_exp_f32 v53, v53
    v_exp_f32 v54, v54
    v_exp_f32 v55, v55
    v_smfmac_f32_32x32x32_bf16 a[48:63], v[140:143], v[104:111], v3
    v_exp_f32 v56, v56
    v_exp_f32 v57, v57
    s_mov_b64 exec, s[88:89]
    buffer_load_dwordx4 v[136:139], v2, s[44:47], s81 offen offset:2048 sc1
    buffer_load_dwordx4 v[140:143], v2, s[44:47], s81 offen offset:3072 sc1
    s_mov_b64 exec, -1
    v_exp_f32 v58, v58
    v_exp_f32 v59, v59
    v_smfmac_f32_32x32x32_bf16 a[0:15], v[152:155], v[48:55], v3
    v_exp_f32 v60, v60
    v_exp_f32 v61, v61
    v_exp_f32 v62, v62
    v_exp_f32 v63, v63
    v_mfma_f32_32x32x16_bf16 v[80:95], v[144:147], v[32:35], 0
    v_exp_f32 v64, v64
    v_exp_f32 v65, v65
    v_exp_f32 v66, v66
    v_exp_f32 v67, v67
    v_mfma_f32_32x32x16_bf16 v[80:95], v[148:151], v[36:39], v[80:95]
    v_exp_f32 v68, v68
    v_exp_f32 v69, v69
    v_exp_f32 v70, v70
    v_exp_f32 v71, v71
    v_smfmac_f32_32x32x32_bf16 a[0:15], v[156:159], v[56:63], v3
    v_exp_f32 v72, v72
    v_exp_f32 v73, v73
    v_exp_f32 v74, v74
    v_exp_f32 v75, v75
    v_smfmac_f32_32x32x32_bf16 a[16:31], v[152:155], v[64:71], v3
    v_exp_f32 v76, v76
    v_exp_f32 v77, v77
    v_exp_f32 v78, v78
    v_exp_f32 v79, v79
    v_mfma_f32_32x32x16_bf16 v[96:111], v[144:147], v[40:43], 0
    v_exp_f32 v80, v80
    v_exp_f32 v81, v81
    v_exp_f32 v82, v82
    v_exp_f32 v83, v83
    v_mfma_f32_32x32x16_bf16 v[96:111], v[148:151], v[44:47], v[96:111]
    v_exp_f32 v84, v84
    v_exp_f32 v85, v85
    buffer_load_dwordx4 v[144:147], v2, s[44:47], s82 offen offset:0 sc1
    buffer_load_dwordx4 v[148:151], v2, s[44:47], s82 offen offset:1024 sc1
    v_exp_f32 v86, v86
    v_exp_f32 v87, v87
    v_smfmac_f32_32x32x32_bf16 a[16:31], v[156:159], v[72:79], v3
    v_exp_f32 v88, v88
    v_exp_f32 v89, v89
    v_exp_f32 v90, v90
    v_exp_f32 v91, v91
    v_smfmac_f32_32x32x32_bf16 a[32:47], v[152:155], v[80:87], v3
    v_exp_f32 v92, v92
    v_exp_f32 v93, v93
    v_exp_f32 v94, v94
    v_exp_f32 v95, v95
    s_waitcnt vmcnt(10)
    v_mfma_f32_32x32x16_bf16 v[48:63], v[160:163], v[16:19], 0
    v_exp_f32 v96, v96
    v_exp_f32 v97, v97
    v_exp_f32 v98, v98
    v_exp_f32 v99, v99
    v_mfma_f32_32x32x16_bf16 v[48:63], v[164:167], v[20:23], v[48:63]
    v_exp_f32 v100, v100
    v_exp_f32 v101, v101
    v_exp_f32 v102, v102
    v_exp_f32 v103, v103
    v_smfmac_f32_32x32x32_bf16 a[32:47], v[156:159], v[88:95], v3
    v_exp_f32 v104, v104
    v_exp_f32 v105, v105
    v_exp_f32 v106, v106
    v_exp_f32 v107, v107
    v_smfmac_f32_32x32x32_bf16 a[48:63], v[152:155], v[96:103], v3
    v_exp_f32 v108, v108
    v_exp_f32 v109, v109
    v_exp_f32 v110, v110
    v_exp_f32 v111, v111
    v_mfma_f32_32x32x16_bf16 v[64:79], v[160:163], v[24:27], 0
    v_exp_f32 v48, v48
    v_exp_f32 v49, v49
    v_exp_f32 v50, v50
    v_exp_f32 v51, v51
    v_mfma_f32_32x32x16_bf16 v[64:79], v[164:167], v[28:31], v[64:79]
    v_exp_f32 v52, v52
    v_exp_f32 v53, v53
    v_exp_f32 v54, v54
    v_exp_f32 v55, v55
    v_smfmac_f32_32x32x32_bf16 a[48:63], v[156:159], v[104:111], v3
    v_exp_f32 v56, v56
    v_exp_f32 v57, v57
    s_mov_b64 exec, s[88:89]
    buffer_load_dwordx4 v[152:155], v2, s[44:47], s82 offen offset:2048 sc1
    buffer_load_dwordx4 v[156:159], v2, s[44:47], s82 offen offset:3072 sc1
    s_mov_b64 exec, -1
    v_exp_f32 v58, v58
    v_exp_f32 v59, v59
    v_smfmac_f32_32x32x32_bf16 a[0:15], v[168:171], v[48:55], v3
    v_exp_f32 v60, v60
    v_exp_f32 v61, v61
    v_exp_f32 v62, v62
    v_exp_f32 v63, v63
    v_mfma_f32_32x32x16_bf16 v[80:95], v[160:163], v[32:35], 0
    v_exp_f32 v64, v64
    v_exp_f32 v65, v65
    v_exp_f32 v66, v66
    v_exp_f32 v67, v67
    v_mfma_f32_32x32x16_bf16 v[80:95], v[164:167], v[36:39], v[80:95]
    v_exp_f32 v68, v68
    v_exp_f32 v69, v69
    v_exp_f32 v70, v70
    v_exp_f32 v71, v71
    v_smfmac_f32_32x32x32_bf16 a[0:15], v[172:175], v[56:63], v3
    v_exp_f32 v72, v72
    v_exp_f32 v73, v73
    v_exp_f32 v74, v74
    v_exp_f32 v75, v75
    v_smfmac_f32_32x32x32_bf16 a[16:31], v[168:171], v[64:71], v3
    v_exp_f32 v76, v76
    v_exp_f32 v77, v77
    v_exp_f32 v78, v78
    v_exp_f32 v79, v79
    v_mfma_f32_32x32x16_bf16 v[96:111], v[160:163], v[40:43], 0
    v_exp_f32 v80, v80
    v_exp_f32 v81, v81
    v_exp_f32 v82, v82
    v_exp_f32 v83, v83
    v_mfma_f32_32x32x16_bf16 v[96:111], v[164:167], v[44:47], v[96:111]
    v_exp_f32 v84, v84
    v_exp_f32 v85, v85
    buffer_load_dwordx4 v[160:163], v2, s[44:47], s83 offen offset:0 sc1
    buffer_load_dwordx4 v[164:167], v2, s[44:47], s83 offen offset:1024 sc1
    v_exp_f32 v86, v86
    v_exp_f32 v87, v87
    v_smfmac_f32_32x32x32_bf16 a[16:31], v[172:175], v[72:79], v3
    v_exp_f32 v88, v88
    v_exp_f32 v89, v89
    v_exp_f32 v90, v90
    v_exp_f32 v91, v91
    v_smfmac_f32_32x32x32_bf16 a[32:47], v[168:171], v[80:87], v3
    v_exp_f32 v92, v92
    v_exp_f32 v93, v93
    v_exp_f32 v94, v94
    v_exp_f32 v95, v95
    s_waitcnt vmcnt(10)
    v_mfma_f32_32x32x16_bf16 v[48:63], v[112:115], v[16:19], 0
    v_exp_f32 v96, v96
    v_exp_f32 v97, v97
    v_exp_f32 v98, v98
    v_exp_f32 v99, v99
    v_mfma_f32_32x32x16_bf16 v[48:63], v[116:119], v[20:23], v[48:63]
    v_exp_f32 v100, v100
    v_exp_f32 v101, v101
    v_exp_f32 v102, v102
    v_exp_f32 v103, v103
    v_smfmac_f32_32x32x32_bf16 a[32:47], v[172:175], v[88:95], v3
    v_exp_f32 v104, v104
    v_exp_f32 v105, v105
    v_exp_f32 v106, v106
    v_exp_f32 v107, v107
    v_smfmac_f32_32x32x32_bf16 a[48:63], v[168:171], v[96:103], v3
    v_exp_f32 v108, v108
    v_exp_f32 v109, v109
    v_exp_f32 v110, v110
    v_exp_f32 v111, v111
    v_mfma_f32_32x32x16_bf16 v[64:79], v[112:115], v[24:27], 0
    v_exp_f32 v48, v48
    v_exp_f32 v49, v49
    v_exp_f32 v50, v50
    v_exp_f32 v51, v51
    v_mfma_f32_32x32x16_bf16 v[64:79], v[116:119], v[28:31], v[64:79]
    v_exp_f32 v52, v52
    v_exp_f32 v53, v53
    v_exp_f32 v54, v54
    v_exp_f32 v55, v55
    v_smfmac_f32_32x32x32_bf16 a[48:63], v[172:175], v[104:111], v3
    v_exp_f32 v56, v56
    v_exp_f32 v57, v57
    s_mov_b64 exec, s[88:89]
    buffer_load_dwordx4 v[168:171], v2, s[44:47], s83 offen offset:2048 sc1
    buffer_load_dwordx4 v[172:175], v2, s[44:47], s83 offen offset:3072 sc1
    s_mov_b64 exec, -1
    v_exp_f32 v58, v58
    v_exp_f32 v59, v59
    v_smfmac_f32_32x32x32_bf16 a[0:15], v[120:123], v[48:55], v3
    v_exp_f32 v60, v60
    v_exp_f32 v61, v61
    v_exp_f32 v62, v62
    v_exp_f32 v63, v63
    v_mfma_f32_32x32x16_bf16 v[80:95], v[112:115], v[32:35], 0
    v_exp_f32 v64, v64
    v_exp_f32 v65, v65
    v_exp_f32 v66, v66
    v_exp_f32 v67, v67
    v_mfma_f32_32x32x16_bf16 v[80:95], v[116:119], v[36:39], v[80:95]
    v_exp_f32 v68, v68
    v_exp_f32 v69, v69
    v_exp_f32 v70, v70
    v_exp_f32 v71, v71
    v_smfmac_f32_32x32x32_bf16 a[0:15], v[124:127], v[56:63], v3
    v_exp_f32 v72, v72
    v_exp_f32 v73, v73
    v_exp_f32 v74, v74
    v_exp_f32 v75, v75
    v_smfmac_f32_32x32x32_bf16 a[16:31], v[120:123], v[64:71], v3
    v_exp_f32 v76, v76
    v_exp_f32 v77, v77
    v_exp_f32 v78, v78
    v_exp_f32 v79, v79
    v_mfma_f32_32x32x16_bf16 v[96:111], v[112:115], v[40:43], 0
    v_exp_f32 v80, v80
    v_exp_f32 v81, v81
    v_exp_f32 v82, v82
    v_exp_f32 v83, v83
    v_mfma_f32_32x32x16_bf16 v[96:111], v[116:119], v[44:47], v[96:111]
    v_exp_f32 v84, v84
    v_exp_f32 v85, v85
    buffer_load_dwordx4 v[112:115], v2, s[44:47], s84 offen offset:0 sc1
    buffer_load_dwordx4 v[116:119], v2, s[44:47], s84 offen offset:1024 sc1
    v_exp_f32 v86, v86
    v_exp_f32 v87, v87
    v_smfmac_f32_32x32x32_bf16 a[16:31], v[124:127], v[72:79], v3
    v_exp_f32 v88, v88
    v_exp_f32 v89, v89
    v_exp_f32 v90, v90
    v_exp_f32 v91, v91
    v_smfmac_f32_32x32x32_bf16 a[32:47], v[120:123], v[80:87], v3
    v_exp_f32 v92, v92
    v_exp_f32 v93, v93
    v_exp_f32 v94, v94
    v_exp_f32 v95, v95
    s_waitcnt vmcnt(10)
    v_mfma_f32_32x32x16_bf16 v[48:63], v[128:131], v[16:19], 0
    v_exp_f32 v96, v96
    v_exp_f32 v97, v97
    v_exp_f32 v98, v98
    v_exp_f32 v99, v99
    v_mfma_f32_32x32x16_bf16 v[48:63], v[132:135], v[20:23], v[48:63]
    v_exp_f32 v100, v100
    v_exp_f32 v101, v101
    v_exp_f32 v102, v102
    v_exp_f32 v103, v103
    v_smfmac_f32_32x32x32_bf16 a[32:47], v[124:127], v[88:95], v3
    v_exp_f32 v104, v104
    v_exp_f32 v105, v105
    v_exp_f32 v106, v106
    v_exp_f32 v107, v107
    v_smfmac_f32_32x32x32_bf16 a[48:63], v[120:123], v[96:103], v3
    v_exp_f32 v108, v108
    v_exp_f32 v109, v109
    v_exp_f32 v110, v110
    v_exp_f32 v111, v111
    v_mfma_f32_32x32x16_bf16 v[64:79], v[128:131], v[24:27], 0
    v_exp_f32 v48, v48
    v_exp_f32 v49, v49
    v_exp_f32 v50, v50
    v_exp_f32 v51, v51
    v_mfma_f32_32x32x16_bf16 v[64:79], v[132:135], v[28:31], v[64:79]
    v_exp_f32 v52, v52
    v_exp_f32 v53, v53
    v_exp_f32 v54, v54
    v_exp_f32 v55, v55
    v_smfmac_f32_32x32x32_bf16 a[48:63], v[124:127], v[104:111], v3
    v_exp_f32 v56, v56
    v_exp_f32 v57, v57
    s_mov_b64 exec, s[88:89]
    buffer_load_dwordx4 v[120:123], v2, s[44:47], s84 offen offset:2048 sc1
    buffer_load_dwordx4 v[124:127], v2, s[44:47], s84 offen offset:3072 sc1
    s_mov_b64 exec, -1
    v_exp_f32 v58, v58
    v_exp_f32 v59, v59
    v_smfmac_f32_32x32x32_bf16 a[0:15], v[136:139], v[48:55], v3
    v_exp_f32 v60, v60
    v_exp_f32 v61, v61
    v_exp_f32 v62, v62
    v_exp_f32 v63, v63
    v_mfma_f32_32x32x16_bf16 v[80:95], v[128:131], v[32:35], 0
    v_exp_f32 v64, v64
    v_exp_f32 v65, v65
    v_exp_f32 v66, v66
    v_exp_f32 v67, v67
    v_mfma_f32_32x32x16_bf16 v[80:95], v[132:135], v[36:39], v[80:95]
    v_exp_f32 v68, v68
    v_exp_f32 v69, v69
    v_exp_f32 v70, v70
    v_exp_f32 v71, v71
    v_smfmac_f32_32x32x32_bf16 a[0:15], v[140:143], v[56:63], v3
    v_exp_f32 v72, v72
    v_exp_f32 v73, v73
    v_exp_f32 v74, v74
    v_exp_f32 v75, v75
    v_smfmac_f32_32x32x32_bf16 a[16:31], v[136:139], v[64:71], v3
    v_exp_f32 v76, v76
    v_exp_f32 v77, v77
    v_exp_f32 v78, v78
    v_exp_f32 v79, v79
    v_mfma_f32_32x32x16_bf16 v[96:111], v[128:131], v[40:43], 0
    v_exp_f32 v80, v80
    v_exp_f32 v81, v81
    v_exp_f32 v82, v82
    v_exp_f32 v83, v83
    v_mfma_f32_32x32x16_bf16 v[96:111], v[132:135], v[44:47], v[96:111]
    v_exp_f32 v84, v84
    v_exp_f32 v85, v85
    buffer_load_dwordx4 v[128:131], v2, s[44:47], s85 offen offset:0 sc1
    buffer_load_dwordx4 v[132:135], v2, s[44:47], s85 offen offset:1024 sc1
    v_exp_f32 v86, v86
    v_exp_f32 v87, v87
    v_smfmac_f32_32x32x32_bf16 a[16:31], v[140:143], v[72:79], v3
    v_exp_f32 v88, v88
    v_exp_f32 v89, v89
    v_exp_f32 v90, v90
    v_exp_f32 v91, v91
    v_smfmac_f32_32x32x32_bf16 a[32:47], v[136:139], v[80:87], v3
    v_exp_f32 v92, v92
    v_exp_f32 v93, v93
    v_exp_f32 v94, v94
    v_exp_f32 v95, v95
    s_waitcnt vmcnt(10)
    v_mfma_f32_32x32x16_bf16 v[48:63], v[144:147], v[16:19], 0
    v_exp_f32 v96, v96
    v_exp_f32 v97, v97
    v_exp_f32 v98, v98
    v_exp_f32 v99, v99
    v_mfma_f32_32x32x16_bf16 v[48:63], v[148:151], v[20:23], v[48:63]
    v_exp_f32 v100, v100
    v_exp_f32 v101, v101
    v_exp_f32 v102, v102
    v_exp_f32 v103, v103
    v_smfmac_f32_32x32x32_bf16 a[32:47], v[140:143], v[88:95], v3
    v_exp_f32 v104, v104
    v_exp_f32 v105, v105
    v_exp_f32 v106, v106
    v_exp_f32 v107, v107
    v_smfmac_f32_32x32x32_bf16 a[48:63], v[136:139], v[96:103], v3
    v_exp_f32 v108, v108
    v_exp_f32 v109, v109
    v_exp_f32 v110, v110
    v_exp_f32 v111, v111
    v_mfma_f32_32x32x16_bf16 v[64:79], v[144:147], v[24:27], 0
    v_exp_f32 v48, v48
    v_exp_f32 v49, v49
    v_exp_f32 v50, v50
    v_exp_f32 v51, v51
    v_mfma_f32_32x32x16_bf16 v[64:79], v[148:151], v[28:31], v[64:79]
    v_exp_f32 v52, v52
    v_exp_f32 v53, v53
    v_exp_f32 v54, v54
    v_exp_f32 v55, v55
    v_smfmac_f32_32x32x32_bf16 a[48:63], v[140:143], v[104:111], v3
    v_exp_f32 v56, v56
    v_exp_f32 v57, v57
    s_mov_b64 exec, s[88:89]
    buffer_load_dwordx4 v[136:139], v2, s[44:47], s85 offen offset:2048 sc1
    buffer_load_dwordx4 v[140:143], v2, s[44:47], s85 offen offset:3072 sc1
    s_mov_b64 exec, -1
    v_exp_f32 v58, v58
    v_exp_f32 v59, v59
    v_smfmac_f32_32x32x32_bf16 a[0:15], v[152:155], v[48:55], v3
    v_exp_f32 v60, v60
    v_exp_f32 v61, v61
    v_exp_f32 v62, v62
    v_exp_f32 v63, v63
    v_mfma_f32_32x32x16_bf16 v[80:95], v[144:147], v[32:35], 0
    v_exp_f32 v64, v64
    v_exp_f32 v65, v65
    v_exp_f32 v66, v66
    v_exp_f32 v67, v67
    v_mfma_f32_32x32x16_bf16 v[80:95], v[148:151], v[36:39], v[80:95]
    v_exp_f32 v68, v68
    v_exp_f32 v69, v69
    v_exp_f32 v70, v70
    v_exp_f32 v71, v71
    v_smfmac_f32_32x32x32_bf16 a[0:15], v[156:159], v[56:63], v3
    v_exp_f32 v72, v72
    v_exp_f32 v73, v73
    v_exp_f32 v74, v74
    v_exp_f32 v75, v75
    v_smfmac_f32_32x32x32_bf16 a[16:31], v[152:155], v[64:71], v3
    v_exp_f32 v76, v76
    v_exp_f32 v77, v77
    v_exp_f32 v78, v78
    v_exp_f32 v79, v79
    v_mfma_f32_32x32x16_bf16 v[96:111], v[144:147], v[40:43], 0
    v_exp_f32 v80, v80
    v_exp_f32 v81, v81
    v_exp_f32 v82, v82
    v_exp_f32 v83, v83
    v_mfma_f32_32x32x16_bf16 v[96:111], v[148:151], v[44:47], v[96:111]
    v_exp_f32 v84, v84
    v_exp_f32 v85, v85
    buffer_load_dwordx4 v[144:147], v2, s[44:47], s86 offen offset:0 sc1
    buffer_load_dwordx4 v[148:151], v2, s[44:47], s86 offen offset:1024 sc1
    v_exp_f32 v86, v86
    v_exp_f32 v87, v87
    v_smfmac_f32_32x32x32_bf16 a[16:31], v[156:159], v[72:79], v3
    v_exp_f32 v88, v88
    v_exp_f32 v89, v89
    v_exp_f32 v90, v90
    v_exp_f32 v91, v91
    v_smfmac_f32_32x32x32_bf16 a[32:47], v[152:155], v[80:87], v3
    v_exp_f32 v92, v92
    v_exp_f32 v93, v93
    v_exp_f32 v94, v94
    v_exp_f32 v95, v95
    s_waitcnt vmcnt(10)
    v_mfma_f32_32x32x16_bf16 v[48:63], v[160:163], v[16:19], 0
    v_exp_f32 v96, v96
    v_exp_f32 v97, v97
    v_exp_f32 v98, v98
    v_exp_f32 v99, v99
    v_mfma_f32_32x32x16_bf16 v[48:63], v[164:167], v[20:23], v[48:63]
    v_exp_f32 v100, v100
    v_exp_f32 v101, v101
    v_exp_f32 v102, v102
    v_exp_f32 v103, v103
    v_smfmac_f32_32x32x32_bf16 a[32:47], v[156:159], v[88:95], v3
    v_exp_f32 v104, v104
    v_exp_f32 v105, v105
    v_exp_f32 v106, v106
    v_exp_f32 v107, v107
    v_smfmac_f32_32x32x32_bf16 a[48:63], v[152:155], v[96:103], v3
    v_exp_f32 v108, v108
    v_exp_f32 v109, v109
    v_exp_f32 v110, v110
    v_exp_f32 v111, v111
    v_mfma_f32_32x32x16_bf16 v[64:79], v[160:163], v[24:27], 0
    v_exp_f32 v48, v48
    v_exp_f32 v49, v49
    v_exp_f32 v50, v50
    v_exp_f32 v51, v51
    v_mfma_f32_32x32x16_bf16 v[64:79], v[164:167], v[28:31], v[64:79]
    v_exp_f32 v52, v52
    v_exp_f32 v53, v53
    v_exp_f32 v54, v54
    v_exp_f32 v55, v55
    v_smfmac_f32_32x32x32_bf16 a[48:63], v[156:159], v[104:111], v3
    v_exp_f32 v56, v56
    v_exp_f32 v57, v57
    s_mov_b64 exec, s[88:89]
    buffer_load_dwordx4 v[152:155], v2, s[44:47], s86 offen offset:2048 sc1
    buffer_load_dwordx4 v[156:159], v2, s[44:47], s86 offen offset:3072 sc1
    s_mov_b64 exec, -1
    v_exp_f32 v58, v58
    v_exp_f32 v59, v59
    v_smfmac_f32_32x32x32_bf16 a[0:15], v[168:171], v[48:55], v3
    v_exp_f32 v60, v60
    v_exp_f32 v61, v61
    v_exp_f32 v62, v62
    v_exp_f32 v63, v63
    v_mfma_f32_32x32x16_bf16 v[80:95], v[160:163], v[32:35], 0
    v_exp_f32 v64, v64
    v_exp_f32 v65, v65
    v_exp_f32 v66, v66
    v_exp_f32 v67, v67
    v_mfma_f32_32x32x16_bf16 v[80:95], v[164:167], v[36:39], v[80:95]
    v_exp_f32 v68, v68
    v_exp_f32 v69, v69
    v_exp_f32 v70, v70
    v_exp_f32 v71, v71
    v_smfmac_f32_32x32x32_bf16 a[0:15], v[172:175], v[56:63], v3
    v_exp_f32 v72, v72
    v_exp_f32 v73, v73
    v_exp_f32 v74, v74
    v_exp_f32 v75, v75
    v_smfmac_f32_32x32x32_bf16 a[16:31], v[168:171], v[64:71], v3
    v_exp_f32 v76, v76
    v_exp_f32 v77, v77
    v_exp_f32 v78, v78
    v_exp_f32 v79, v79
    v_mfma_f32_32x32x16_bf16 v[96:111], v[160:163], v[40:43], 0
    v_exp_f32 v80, v80
    v_exp_f32 v81, v81
    v_exp_f32 v82, v82
    v_exp_f32 v83, v83
    v_mfma_f32_32x32x16_bf16 v[96:111], v[164:167], v[44:47], v[96:111]
    v_exp_f32 v84, v84
    v_exp_f32 v85, v85
    buffer_load_dwordx4 v[160:163], v2, s[44:47], s87 offen offset:0 sc1
    buffer_load_dwordx4 v[164:167], v2, s[44:47], s87 offen offset:1024 sc1
    v_exp_f32 v86, v86
    v_exp_f32 v87, v87
    v_smfmac_f32_32x32x32_bf16 a[16:31], v[172:175], v[72:79], v3
    v_exp_f32 v88, v88
    v_exp_f32 v89, v89
    v_exp_f32 v90, v90
    v_exp_f32 v91, v91
    v_smfmac_f32_32x32x32_bf16 a[32:47], v[168:171], v[80:87], v3
    v_exp_f32 v92, v92
    v_exp_f32 v93, v93
    v_exp_f32 v94, v94
    v_exp_f32 v95, v95
    s_waitcnt vmcnt(10)
    v_mfma_f32_32x32x16_bf16 v[48:63], v[112:115], v[16:19], 0
    v_exp_f32 v96, v96
    v_exp_f32 v97, v97
    v_exp_f32 v98, v98
    v_exp_f32 v99, v99
    v_mfma_f32_32x32x16_bf16 v[48:63], v[116:119], v[20:23], v[48:63]
    v_exp_f32 v100, v100
    v_exp_f32 v101, v101
    v_exp_f32 v102, v102
    v_exp_f32 v103, v103
    v_smfmac_f32_32x32x32_bf16 a[32:47], v[172:175], v[88:95], v3
    v_exp_f32 v104, v104
    v_exp_f32 v105, v105
    v_exp_f32 v106, v106
    v_exp_f32 v107, v107
    v_smfmac_f32_32x32x32_bf16 a[48:63], v[168:171], v[96:103], v3
    v_exp_f32 v108, v108
    v_exp_f32 v109, v109
    v_exp_f32 v110, v110
    v_exp_f32 v111, v111
    v_mfma_f32_32x32x16_bf16 v[64:79], v[112:115], v[24:27], 0
    v_exp_f32 v48, v48
    v_exp_f32 v49, v49
    v_exp_f32 v50, v50
    v_exp_f32 v51, v51
    v_mfma_f32_32x32x16_bf16 v[64:79], v[116:119], v[28:31], v[64:79]
    v_exp_f32 v52, v52
    v_exp_f32 v53, v53
    v_exp_f32 v54, v54
    v_exp_f32 v55, v55
    v_smfmac_f32_32x32x32_bf16 a[48:63], v[172:175], v[104:111], v3
    v_exp_f32 v56, v56
    v_exp_f32 v57, v57
    s_mov_b64 exec, s[88:89]
    buffer_load_dwordx4 v[168:171], v2, s[44:47], s87 offen offset:2048 sc1
    buffer_load_dwordx4 v[172:175], v2, s[44:47], s87 offen offset:3072 sc1
    s_mov_b64 exec, -1
    v_exp_f32 v58, v58
    v_exp_f32 v59, v59
    v_smfmac_f32_32x32x32_bf16 a[0:15], v[120:123], v[48:55], v3
    v_exp_f32 v60, v60
    v_exp_f32 v61, v61
    v_exp_f32 v62, v62
    v_exp_f32 v63, v63
    v_mfma_f32_32x32x16_bf16 v[80:95], v[112:115], v[32:35], 0
    v_exp_f32 v64, v64
    v_exp_f32 v65, v65
    v_exp_f32 v66, v66
    v_exp_f32 v67, v67
    v_mfma_f32_32x32x16_bf16 v[80:95], v[116:119], v[36:39], v[80:95]
    v_exp_f32 v68, v68
    v_exp_f32 v69, v69
    v_exp_f32 v70, v70
    v_exp_f32 v71, v71
    v_smfmac_f32_32x32x32_bf16 a[0:15], v[124:127], v[56:63], v3
    v_exp_f32 v72, v72
    v_exp_f32 v73, v73
    v_exp_f32 v74, v74
    v_exp_f32 v75, v75
    v_smfmac_f32_32x32x32_bf16 a[16:31], v[120:123], v[64:71], v3
    v_exp_f32 v76, v76
    v_exp_f32 v77, v77
    v_exp_f32 v78, v78
    v_exp_f32 v79, v79
    v_mfma_f32_32x32x16_bf16 v[96:111], v[112:115], v[40:43], 0
    v_exp_f32 v80, v80
    v_exp_f32 v81, v81
    v_exp_f32 v82, v82
    v_exp_f32 v83, v83
    v_mfma_f32_32x32x16_bf16 v[96:111], v[116:119], v[44:47], v[96:111]
    v_exp_f32 v84, v84
    v_exp_f32 v85, v85
    v_exp_f32 v86, v86
    v_exp_f32 v87, v87
    v_smfmac_f32_32x32x32_bf16 a[16:31], v[124:127], v[72:79], v3
    v_exp_f32 v88, v88
    v_exp_f32 v89, v89
    v_exp_f32 v90, v90
    v_exp_f32 v91, v91
    v_smfmac_f32_32x32x32_bf16 a[32:47], v[120:123], v[80:87], v3
    v_exp_f32 v92, v92
    v_exp_f32 v93, v93
    v_exp_f32 v94, v94
    v_exp_f32 v95, v95
    s_waitcnt vmcnt(8)
    v_mfma_f32_32x32x16_bf16 v[48:63], v[128:131], v[16:19], 0
    v_exp_f32 v96, v96
    v_exp_f32 v97, v97
    v_exp_f32 v98, v98
    v_exp_f32 v99, v99
    v_mfma_f32_32x32x16_bf16 v[48:63], v[132:135], v[20:23], v[48:63]
    v_exp_f32 v100, v100
    v_exp_f32 v101, v101
    v_exp_f32 v102, v102
    v_exp_f32 v103, v103
    v_smfmac_f32_32x32x32_bf16 a[32:47], v[124:127], v[88:95], v3
    v_exp_f32 v104, v104
    v_exp_f32 v105, v105
    v_exp_f32 v106, v106
    v_exp_f32 v107, v107
    v_smfmac_f32_32x32x32_bf16 a[48:63], v[120:123], v[96:103], v3
    v_exp_f32 v108, v108
    v_exp_f32 v109, v109
    v_exp_f32 v110, v110
    v_exp_f32 v111, v111
    v_mfma_f32_32x32x16_bf16 v[64:79], v[128:131], v[24:27], 0
    v_exp_f32 v48, v48
    v_exp_f32 v49, v49
    v_exp_f32 v50, v50
    v_exp_f32 v51, v51
    v_mfma_f32_32x32x16_bf16 v[64:79], v[132:135], v[28:31], v[64:79]
    v_exp_f32 v52, v52
    v_exp_f32 v53, v53
    v_exp_f32 v54, v54
    v_exp_f32 v55, v55
    v_smfmac_f32_32x32x32_bf16 a[48:63], v[124:127], v[104:111], v3
    v_exp_f32 v56, v56
    v_exp_f32 v57, v57
    v_exp_f32 v58, v58
    v_exp_f32 v59, v59
    v_smfmac_f32_32x32x32_bf16 a[0:15], v[136:139], v[48:55], v3
    v_exp_f32 v60, v60
    v_exp_f32 v61, v61
    v_exp_f32 v62, v62
    v_exp_f32 v63, v63
    v_mfma_f32_32x32x16_bf16 v[80:95], v[128:131], v[32:35], 0
    v_exp_f32 v64, v64
    v_exp_f32 v65, v65
    v_exp_f32 v66, v66
    v_exp_f32 v67, v67
    v_mfma_f32_32x32x16_bf16 v[80:95], v[132:135], v[36:39], v[80:95]
    v_exp_f32 v68, v68
    v_exp_f32 v69, v69
    v_exp_f32 v70, v70
    v_exp_f32 v71, v71
    v_smfmac_f32_32x32x32_bf16 a[0:15], v[140:143], v[56:63], v3
    v_exp_f32 v72, v72
    v_exp_f32 v73, v73
    v_exp_f32 v74, v74
    v_exp_f32 v75, v75
    v_smfmac_f32_32x32x32_bf16 a[16:31], v[136:139], v[64:71], v3
    v_exp_f32 v76, v76
    v_exp_f32 v77, v77
    v_exp_f32 v78, v78
    v_exp_f32 v79, v79
    v_mfma_f32_32x32x16_bf16 v[96:111], v[128:131], v[40:43], 0
    v_exp_f32 v80, v80
    v_exp_f32 v81, v81
    v_exp_f32 v82, v82
    v_exp_f32 v83, v83
    v_mfma_f32_32x32x16_bf16 v[96:111], v[132:135], v[44:47], v[96:111]
    v_exp_f32 v84, v84
    v_exp_f32 v85, v85
    v_exp_f32 v86, v86
    v_exp_f32 v87, v87
    v_smfmac_f32_32x32x32_bf16 a[16:31], v[140:143], v[72:79], v3
    v_exp_f32 v88, v88
    v_exp_f32 v89, v89
    v_exp_f32 v90, v90
    v_exp_f32 v91, v91
    v_smfmac_f32_32x32x32_bf16 a[32:47], v[136:139], v[80:87], v3
    v_exp_f32 v92, v92
    v_exp_f32 v93, v93
    v_exp_f32 v94, v94
    v_exp_f32 v95, v95
    s_waitcnt vmcnt(4)
    v_mfma_f32_32x32x16_bf16 v[48:63], v[144:147], v[16:19], 0
    v_exp_f32 v96, v96
    v_exp_f32 v97, v97
    v_exp_f32 v98, v98
    v_exp_f32 v99, v99
    v_mfma_f32_32x32x16_bf16 v[48:63], v[148:151], v[20:23], v[48:63]
    v_exp_f32 v100, v100
    v_exp_f32 v101, v101
    v_exp_f32 v102, v102
    v_exp_f32 v103, v103
    v_smfmac_f32_32x32x32_bf16 a[32:47], v[140:143], v[88:95], v3
    v_exp_f32 v104, v104
    v_exp_f32 v105, v105
    v_exp_f32 v106, v106
    v_exp_f32 v107, v107
    v_smfmac_f32_32x32x32_bf16 a[48:63], v[136:139], v[96:103], v3
    v_exp_f32 v108, v108
    v_exp_f32 v109, v109
    v_exp_f32 v110, v110
    v_exp_f32 v111, v111
    v_mfma_f32_32x32x16_bf16 v[64:79], v[144:147], v[24:27], 0
    v_exp_f32 v48, v48
    v_exp_f32 v49, v49
    v_exp_f32 v50, v50
    v_exp_f32 v51, v51
    v_mfma_f32_32x32x16_bf16 v[64:79], v[148:151], v[28:31], v[64:79]
    v_exp_f32 v52, v52
    v_exp_f32 v53, v53
    v_exp_f32 v54, v54
    v_exp_f32 v55, v55
    v_smfmac_f32_32x32x32_bf16 a[48:63], v[140:143], v[104:111], v3
    v_exp_f32 v56, v56
    v_exp_f32 v57, v57
    v_exp_f32 v58, v58
    v_exp_f32 v59, v59
    v_smfmac_f32_32x32x32_bf16 a[0:15], v[152:155], v[48:55], v3
    v_exp_f32 v60, v60
    v_exp_f32 v61, v61
    v_exp_f32 v62, v62
    v_exp_f32 v63, v63
    v_mfma_f32_32x32x16_bf16 v[80:95], v[144:147], v[32:35], 0
    v_exp_f32 v64, v64
    v_exp_f32 v65, v65
    v_exp_f32 v66, v66
    v_exp_f32 v67, v67
    v_mfma_f32_32x32x16_bf16 v[80:95], v[148:151], v[36:39], v[80:95]
    v_exp_f32 v68, v68
    v_exp_f32 v69, v69
    v_exp_f32 v70, v70
    v_exp_f32 v71, v71
    v_smfmac_f32_32x32x32_bf16 a[0:15], v[156:159], v[56:63], v3
    v_exp_f32 v72, v72
    v_exp_f32 v73, v73
    v_exp_f32 v74, v74
    v_exp_f32 v75, v75
    v_smfmac_f32_32x32x32_bf16 a[16:31], v[152:155], v[64:71], v3
    v_exp_f32 v76, v76
    v_exp_f32 v77, v77
    v_exp_f32 v78, v78
    v_exp_f32 v79, v79
    v_mfma_f32_32x32x16_bf16 v[96:111], v[144:147], v[40:43], 0
    v_exp_f32 v80, v80
    v_exp_f32 v81, v81
    v_exp_f32 v82, v82
    v_exp_f32 v83, v83
    v_mfma_f32_32x32x16_bf16 v[96:111], v[148:151], v[44:47], v[96:111]
    v_exp_f32 v84, v84
    v_exp_f32 v85, v85
    v_exp_f32 v86, v86
    v_exp_f32 v87, v87
    v_smfmac_f32_32x32x32_bf16 a[16:31], v[156:159], v[72:79], v3
    v_exp_f32 v88, v88
    v_exp_f32 v89, v89
    v_exp_f32 v90, v90
    v_exp_f32 v91, v91
    v_smfmac_f32_32x32x32_bf16 a[32:47], v[152:155], v[80:87], v3
    v_exp_f32 v92, v92
    v_exp_f32 v93, v93
    v_exp_f32 v94, v94
    v_exp_f32 v95, v95
    s_waitcnt vmcnt(0)
    v_mfma_f32_32x32x16_bf16 v[48:63], v[160:163], v[16:19], 0
    v_exp_f32 v96, v96
    v_exp_f32 v97, v97
    v_exp_f32 v98, v98
    v_exp_f32 v99, v99
    v_mfma_f32_32x32x16_bf16 v[48:63], v[164:167], v[20:23], v[48:63]
    v_exp_f32 v100, v100
    v_exp_f32 v101, v101
    v_exp_f32 v102, v102
    v_exp_f32 v103, v103
    v_smfmac_f32_32x32x32_bf16 a[32:47], v[156:159], v[88:95], v3
    v_exp_f32 v104, v104
    v_exp_f32 v105, v105
    v_exp_f32 v106, v106
    v_exp_f32 v107, v107
    v_smfmac_f32_32x32x32_bf16 a[48:63], v[152:155], v[96:103], v3
    v_exp_f32 v108, v108
    v_exp_f32 v109, v109
    v_exp_f32 v110, v110
    v_exp_f32 v111, v111
    v_mfma_f32_32x32x16_bf16 v[64:79], v[160:163], v[24:27], 0
    v_exp_f32 v48, v48
    v_exp_f32 v49, v49
    v_exp_f32 v50, v50
    v_exp_f32 v51, v51
    v_mfma_f32_32x32x16_bf16 v[64:79], v[164:167], v[28:31], v[64:79]
    v_exp_f32 v52, v52
    v_exp_f32 v53, v53
    v_exp_f32 v54, v54
    v_exp_f32 v55, v55
    v_smfmac_f32_32x32x32_bf16 a[48:63], v[156:159], v[104:111], v3
    v_exp_f32 v56, v56
    v_exp_f32 v57, v57
    v_exp_f32 v58, v58
    v_exp_f32 v59, v59
    v_smfmac_f32_32x32x32_bf16 a[0:15], v[168:171], v[48:55], v3
    v_exp_f32 v60, v60
    v_exp_f32 v61, v61
    v_exp_f32 v62, v62
    v_exp_f32 v63, v63
    v_mfma_f32_32x32x16_bf16 v[80:95], v[160:163], v[32:35], 0
    v_exp_f32 v64, v64
    v_exp_f32 v65, v65
    v_exp_f32 v66, v66
    v_exp_f32 v67, v67
    v_mfma_f32_32x32x16_bf16 v[80:95], v[164:167], v[36:39], v[80:95]
    v_exp_f32 v68, v68
    v_exp_f32 v69, v69
    v_exp_f32 v70, v70
    v_exp_f32 v71, v71
    v_smfmac_f32_32x32x32_bf16 a[0:15], v[172:175], v[56:63], v3
    v_exp_f32 v72, v72
    v_exp_f32 v73, v73
    v_exp_f32 v74, v74
    v_exp_f32 v75, v75
    v_smfmac_f32_32x32x32_bf16 a[16:31], v[168:171], v[64:71], v3
    v_exp_f32 v76, v76
    v_exp_f32 v77, v77
    v_exp_f32 v78, v78
    v_exp_f32 v79, v79
    v_mfma_f32_32x32x16_bf16 v[96:111], v[160:163], v[40:43], 0
    v_exp_f32 v80, v80
    v_exp_f32 v81, v81
    v_exp_f32 v82, v82
    v_exp_f32 v83, v83
    v_mfma_f32_32x32x16_bf16 v[96:111], v[164:167], v[44:47], v[96:111]
    v_exp_f32 v84, v84
    v_exp_f32 v85, v85
    v_exp_f32 v86, v86
    v_exp_f32 v87, v87
    v_smfmac_f32_32x32x32_bf16 a[16:31], v[172:175], v[72:79], v3
    v_exp_f32 v88, v88
    v_exp_f32 v89, v89
    ds_write_b128 v6, a[0:3] offset:0
    v_exp_f32 v90, v90
    v_exp_f32 v91, v91
    ds_write_b128 v6, a[4:7] offset:1024
    v_smfmac_f32_32x32x32_bf16 a[32:47], v[168:171], v[80:87], v3
    v_exp_f32 v92, v92
    v_exp_f32 v93, v93
    ds_write_b128 v6, a[8:11] offset:2048
    v_exp_f32 v94, v94
    v_exp_f32 v95, v95
    ds_write_b128 v6, a[12:15] offset:3072
    v_exp_f32 v96, v96
    v_exp_f32 v97, v97
    v_exp_f32 v98, v98
    v_exp_f32 v99, v99
    v_exp_f32 v100, v100
    v_exp_f32 v101, v101
    v_exp_f32 v102, v102
    v_exp_f32 v103, v103
    v_smfmac_f32_32x32x32_bf16 a[32:47], v[172:175], v[88:95], v3
    v_exp_f32 v104, v104
    v_exp_f32 v105, v105
    ds_write_b128 v7, a[16:19] offset:0
    v_exp_f32 v106, v106
    v_exp_f32 v107, v107
    ds_write_b128 v7, a[20:23] offset:1024
    v_smfmac_f32_32x32x32_bf16 a[48:63], v[168:171], v[96:103], v3
    v_exp_f32 v108, v108
    v_exp_f32 v109, v109
    ds_write_b128 v7, a[24:27] offset:2048
    v_exp_f32 v110, v110
    v_exp_f32 v111, v111
    ds_write_b128 v7, a[28:31] offset:3072
    s_nop 1
    v_smfmac_f32_32x32x32_bf16 a[48:63], v[172:175], v[104:111], v3
    s_mul_i32 s7, s69, 12288
    s_add_u32 s7, s7, 74880
    v_add_u32 v13, s7, v2
    ds_write_b128 v8, a[32:35] offset:0
    ds_write_b128 v8, a[36:39] offset:1024
    ds_write_b128 v8, a[40:43] offset:2048
    ds_write_b128 v8, a[44:47] offset:3072
    s_lshl_b32 s7, s71, 2
    s_add_u32 s9, s7, s69
    s_lshl_b32 s12, s9, 15
    s_lshl_b32 s8, s70, 11
    s_add_u32 s12, s12, s8
    s_add_u32 s12, s12, 0xa00000
    s_lshl_b32 s13, s9, 4
    s_add_u32 s13, s13, s70
    s_lshl_b32 s13, s13, 7
    s_add_u32 s13, s13, 0xcf0000
    s_cmp_eq_u32 s6, -1
    s_cbranch_scc1 L_SAFE_SYNC
    s_waitcnt lgkmcnt(0)
    s_barrier
L_SAFE_BACK:
    ds_read_b32 v11, v9 offset:24
    ds_read_b128 v[76:79], v13 offset:3072
    ds_read_b128 v[72:75], v13 offset:2048
    ds_read_b128 v[64:67], v13 offset:0
    ds_read_b128 v[68:71], v13 offset:1024
    ds_read_b128 v[92:95], v13 offset:7168
    ds_read_b128 v[88:91], v13 offset:6144
    ds_read_b128 v[80:83], v13 offset:4096
    ds_read_b128 v[84:87], v13 offset:5120
    ds_read_b128 v[108:111], v13 offset:11264
    ds_read_b128 v[104:107], v13 offset:10240
    ds_read_b128 v[96:99], v13 offset:8192
    ds_read_b128 v[100:103], v13 offset:9216
    v_accvgpr_read_b32 v48, a48
    v_accvgpr_read_b32 v49, a49
    v_accvgpr_read_b32 v50, a50
    v_accvgpr_read_b32 v51, a51
    v_accvgpr_read_b32 v52, a52
    v_accvgpr_read_b32 v53, a53
    v_accvgpr_read_b32 v54, a54
    v_accvgpr_read_b32 v55, a55
    v_accvgpr_read_b32 v56, a56
    v_accvgpr_read_b32 v57, a57
    v_accvgpr_read_b32 v58, a58
    v_accvgpr_read_b32 v59, a59
    v_accvgpr_read_b32 v60, a60
    v_accvgpr_read_b32 v61, a61
    v_accvgpr_read_b32 v62, a62
    v_accvgpr_read_b32 v63, a63
    s_waitcnt lgkmcnt(8)
    v_pk_add_f32 v[60:61], v[60:61], v[76:77]
    v_pk_add_f32 v[62:63], v[62:63], v[78:79]
    v_pk_add_f32 v[56:57], v[56:57], v[72:73]
    v_pk_add_f32 v[58:59], v[58:59], v[74:75]
    v_pk_add_f32 v[48:49], v[48:49], v[64:65]
    v_pk_add_f32 v[50:51], v[50:51], v[66:67]
    v_pk_add_f32 v[52:53], v[52:53], v[68:69]
    v_pk_add_f32 v[54:55], v[54:55], v[70:71]
    s_waitcnt lgkmcnt(4)
    v_pk_add_f32 v[60:61], v[60:61], v[92:93]
    v_pk_add_f32 v[62:63], v[62:63], v[94:95]
    v_pk_add_f32 v[56:57], v[56:57], v[88:89]
    v_pk_add_f32 v[58:59], v[58:59], v[90:91]
    v_pk_add_f32 v[48:49], v[48:49], v[80:81]
    v_pk_add_f32 v[50:51], v[50:51], v[82:83]
    v_pk_add_f32 v[52:53], v[52:53], v[84:85]
    v_pk_add_f32 v[54:55], v[54:55], v[86:87]
    s_waitcnt lgkmcnt(0)
    v_pk_add_f32 v[60:61], v[60:61], v[108:109]
    v_pk_add_f32 v[62:63], v[62:63], v[110:111]
    v_pk_add_f32 v[56:57], v[56:57], v[104:105]
    v_pk_add_f32 v[58:59], v[58:59], v[106:107]
    v_pk_add_f32 v[48:49], v[48:49], v[96:97]
    v_pk_add_f32 v[50:51], v[50:51], v[98:99]
    v_pk_add_f32 v[52:53], v[52:53], v[100:101]
    v_pk_add_f32 v[54:55], v[54:55], v[102:103]
    v_mov_b32 v12, v60
    v_mov_b32 v14, v60
    s_mov_b32 s8, 0x2b800000
    s_mov_b32 s9, 0x67800000
    v_permlane32_swap_b32 v14, v12
    v_readfirstlane_b32 s15, v11
    s_nop 0
    v_rcp_f32 v14, v12
    v_cmp_nle_f32 s[10:11], s8, v12
    v_cmp_nge_f32 vcc, s9, v12
    v_pk_mul_f32 v[48:49], v[48:49], v[14:15] op_sel_hi:[1,0]
    v_pk_mul_f32 v[50:51], v[50:51], v[14:15] op_sel_hi:[1,0]
    v_pk_mul_f32 v[52:53], v[52:53], v[14:15] op_sel_hi:[1,0]
    v_pk_mul_f32 v[54:55], v[54:55], v[14:15] op_sel_hi:[1,0]
    v_cvt_pk_bf16_f32 v64, v48, v49
    v_cvt_pk_bf16_f32 v65, v50, v51
    v_cvt_pk_bf16_f32 v66, v52, v53
    v_cvt_pk_bf16_f32 v67, v54, v55
    v_pk_mul_f32 v[56:57], v[56:57], v[14:15] op_sel_hi:[1,0]
    v_pk_mul_f32 v[58:59], v[58:59], v[14:15] op_sel_hi:[1,0]
    v_pk_mul_f32 v[60:61], v[60:61], v[14:15] op_sel_hi:[1,0]
    v_pk_mul_f32 v[62:63], v[62:63], v[14:15] op_sel_hi:[1,0]
    v_cvt_pk_bf16_f32 v68, v56, v57
    v_cvt_pk_bf16_f32 v69, v58, v59
    v_cvt_pk_bf16_f32 v70, v60, v61
    v_cvt_pk_bf16_f32 v71, v62, v63
    s_cmp_eq_u32 s15, 0
    s_cbranch_scc1 L_OS_FAR
    buffer_store_dwordx4 v[64:67], v2, s[44:47], s12 offen offset:0 nt
    buffer_store_dwordx4 v[68:71], v2, s[44:47], s12 offen offset:1024 nt
L_OS_BACK:
    s_or_b64 s[10:11], s[10:11], vcc
    v_pk_mul_f32 v[12:13], v[48:49], 0
    v_pk_fma_f32 v[12:13], v[50:51], 0, v[12:13]
    v_pk_fma_f32 v[12:13], v[52:53], 0, v[12:13]
    v_pk_fma_f32 v[12:13], v[54:55], 0, v[12:13]
    v_pk_fma_f32 v[12:13], v[56:57], 0, v[12:13]
    v_pk_fma_f32 v[12:13], v[58:59], 0, v[12:13]
    v_pk_fma_f32 v[12:13], v[60:61], 0, v[12:13]
    v_pk_fma_f32 v[12:13], v[62:63], 0, v[12:13]
    v_cmp_u_f32 vcc, v12, v13
    s_or_b64 s[10:11], s[10:11], vcc
    s_cselect_b32 s7, 0x10001, 1
    v_mov_b32 v11, 148864
    v_mov_b32 v12, s7
    s_add_u32 s99, s99, 4
    s_waitcnt lgkmcnt(0)
    s_mov_b64 exec, 1
    ds_add_u32 v11, v12 offset:12
    s_mov_b64 exec, -1
    s_mov_b32 s98, 2097152
LSPIN_29:
    ds_read_b32 v12, v11 offset:12
    s_waitcnt lgkmcnt(0)
    v_cmp_le_u16 vcc, s99, v12
    s_cbranch_vccz RETRY_30
    v_cmp_lt_u32 vcc, s6, v12
    s_cbranch_vccnz L_SLOW
    s_cmp_eq_u32 s15, 0
    s_cbranch_scc1 L_OF_FAR
    v_mov_b32 v8, s68
    v_mov_b32 v9, s68
    v_mov_b32 v10, s68
    v_mov_b32 v11, s68
    s_waitcnt vmcnt(0)
    s_mov_b64 exec, 0xff
    buffer_store_dwordx4 v[8:11], v2, s[44:47], s13 offen
    s_mov_b64 exec, -1
L_OF_BACK:
L_END:
    s_endpgm
L_OF_FAR:
    v_mov_b32 v8, s68
    v_mov_b32 v9, s68
    v_mov_b32 v10, s68
    v_mov_b32 v11, s68
    s_waitcnt vmcnt(0)
    s_mov_b64 exec, 0xff
    buffer_store_dwordx4 v[8:11], v2, s[44:47], s13 offen sc1
    s_mov_b64 exec, -1
    s_branch L_OF_BACK
L_LATE:
    s_mov_b32 s98, 131072
    s_mov_b64 exec, vcc
POLL_31:
    buffer_load_dword v183, v182, s[44:47], 0 offen sc1
    s_waitcnt vmcnt(0)
    v_cmp_ne_u32 vcc, s68, v183
    s_cbranch_vccnz RETRY_32
    s_mov_b64 exec, -1
    s_branch L_LATE_BACK
L_SAFE_SYNC:
    v_mov_b32 v11, 148864
    v_mov_b32 v12, 1
    s_add_u32 s99, s99, 4
    s_waitcnt lgkmcnt(0)
    s_mov_b64 exec, 1
    ds_add_u32 v11, v12 offset:12
    s_mov_b64 exec, -1
    s_mov_b32 s98, 2097152
LSPIN_33:
    ds_read_b32 v12, v11 offset:12
    s_waitcnt lgkmcnt(0)
    v_cmp_le_u16 vcc, s99, v12
    s_cbranch_vccz RETRY_34
    s_branch L_SAFE_BACK
L_SLOW:
    s_mov_b32 s6, -1
    s_mov_b32 s8, 0
    v_mov_b32 v176, 0xff7fffff
    v_mov_b32 v177, 0xff7fffff
    v_mov_b32 v178, 0xff7fffff
    v_mov_b32 v179, 0xff7fffff
L_MAXLOOP:
    s_add_u32 s7, s91, s8
    buffer_load_dwordx4 v[112:115], v2, s[44:47], s7 offen sc1
    buffer_load_dwordx4 v[116:119], v2, s[44:47], s7 offen offset:1024 sc1
    s_waitcnt vmcnt(0)
    v_mfma_f32_32x32x16_bf16 v[48:63], v[112:115], v[16:19], 0
    v_mfma_f32_32x32x16_bf16 v[48:63], v[116:119], v[20:23], v[48:63]
    v_mfma_f32_32x32x16_bf16 v[64:79], v[112:115], v[24:27], 0
    v_mfma_f32_32x32x16_bf16 v[64:79], v[116:119], v[28:31], v[64:79]
    v_mfma_f32_32x32x16_bf16 v[80:95], v[112:115], v[32:35], 0
    v_mfma_f32_32x32x16_bf16 v[80:95], v[116:119], v[36:39], v[80:95]
    v_mfma_f32_32x32x16_bf16 v[96:111], v[112:115], v[40:43], 0
    v_mfma_f32_32x32x16_bf16 v[96:111], v[116:119], v[44:47], v[96:111]
    s_nop 7
    s_nop 7
    v_max3_f32 v176, v48, v49, v176
    v_max3_f32 v176, v50, v51, v176
    v_max3_f32 v176, v52, v53, v176
    v_max3_f32 v176, v54, v55, v176
    v_max3_f32 v176, v56, v57, v176
    v_max3_f32 v176, v58, v59, v176
    v_max3_f32 v176, v60, v61, v176
    v_max3_f32 v176, v62, v63, v176
    v_max3_f32 v177, v64, v65, v177
    v_max3_f32 v177, v66, v67, v177
    v_max3_f32 v177, v68, v69, v177
    v_max3_f32 v177, v70, v71, v177
    v_max3_f32 v177, v72, v73, v177
    v_max3_f32 v177, v74, v75, v177
    v_max3_f32 v177, v76, v77, v177
    v_max3_f32 v177, v78, v79, v177
    v_max3_f32 v178, v80, v81, v178
    v_max3_f32 v178, v82, v83, v178
    v_max3_f32 v178, v84, v85, v178
    v_max3_f32 v178, v86, v87, v178
    v_max3_f32 v178, v88, v89, v178
    v_max3_f32 v178, v90, v91, v178
    v_max3_f32 v178, v92, v93, v178
    v_max3_f32 v178, v94, v95, v178
    v_max3_f32 v179, v96, v97, v179
    v_max3_f32 v179, v98, v99, v179
    v_max3_f32 v179, v100, v101, v179
    v_max3_f32 v179, v102, v103, v179
    v_max3_f32 v179, v104, v105, v179
    v_max3_f32 v179, v106, v107, v179
    v_max3_f32 v179, v108, v109, v179
    v_max3_f32 v179, v110, v111, v179
    s_add_u32 s8, s8, 4096
    s_cmp_lt_u32 s8, 65536
    s_cbranch_scc1 L_MAXLOOP
    s_add_u32 s7, s69, 1
    s_and_b32 s7, s7, 3
    s_lshl_b32 s7, s7, 10
    s_lshl_b32 s8, s69, 8
    s_add_u32 s7, s7, s8
    s_add_u32 s7, s7, 74880
    v_lshl_add_u32 v11, v1, 2, s7
    ds_write_b32 v11, v176
    s_add_u32 s7, s69, 2
    s_and_b32 s7, s7, 3
    s_lshl_b32 s7, s7, 10
    s_lshl_b32 s8, s69, 8
    s_add_u32 s7, s7, s8
    s_add_u32 s7, s7, 74880
    v_lshl_add_u32 v11, v1, 2, s7
    ds_write_b32 v11, v177
    s_add_u32 s7, s69, 3
    s_and_b32 s7, s7, 3
    s_lshl_b32 s7, s7, 10
    s_lshl_b32 s8, s69, 8
    s_add_u32 s7, s7, s8
    s_add_u32 s7, s7, 74880
    v_lshl_add_u32 v11, v1, 2, s7
    ds_write_b32 v11, v178
    s_add_u32 s7, s69, 4
    s_and_b32 s7, s7, 3
    s_lshl_b32 s7, s7, 10
    s_lshl_b32 s8, s69, 8
    s_add_u32 s7, s7, s8
    s_add_u32 s7, s7, 74880
    v_lshl_add_u32 v11, v1, 2, s7
    ds_write_b32 v11, v179
    s_lshl_b32 s7, s69, 10
    s_add_u32 s7, s7, 74880
    v_lshl_add_u32 v13, v4, 2, s7
    v_mov_b32 v11, 148864
    v_mov_b32 v12, 1
    s_add_u32 s99, s99, 4
    s_waitcnt lgkmcnt(0)
    s_mov_b64 exec, 1
    ds_add_u32 v11, v12 offset:12
    s_mov_b64 exec, -1
    s_mov_b32 s98, 2097152
LSPIN_35:
    ds_read_b32 v12, v11 offset:12
    s_waitcnt lgkmcnt(0)
    v_cmp_le_u16 vcc, s99, v12
    s_cbranch_vccz RETRY_36
    ds_read_b32 v48, v13 offset:0
    ds_read_b32 v49, v13 offset:128
    ds_read_b32 v50, v13 offset:256
    ds_read_b32 v51, v13 offset:384
    ds_read_b32 v52, v13 offset:512
    ds_read_b32 v53, v13 offset:640
    ds_read_b32 v54, v13 offset:768
    ds_read_b32 v55, v13 offset:896
    s_waitcnt lgkmcnt(0)
    v_max_f32 v48, v48, v49
    v_max_f32 v48, v48, v50
    v_max_f32 v48, v48, v51
    v_max_f32 v48, v48, v52
    v_max_f32 v48, v48, v53
    v_max_f32 v48, v48, v54
    v_max_f32 v48, v48, v55
    v_sub_f32 v12, 0, v48
    v_and_b32 v13, 0xffff0000, v12
    v_sub_f32 v12, v12, v13
    v_and_b32 v14, 0xffff0000, v12
    v_sub_f32 v12, v12, v14
    v_lshrrev_b32 v13, 16, v13
    v_or_b32 v56, v13, v14
    v_lshrrev_b32 v57, 16, v12
    s_and_b32 s8, s70, 1
    s_cmp_eq_u32 s8, 0
    s_cselect_b32 s8, 1544, 0
    s_add_u32 s7, s95, s8
    v_lshlrev_b32 v11, 4, v4
    buffer_store_dwordx2 v[56:57], v11, s[44:47], s7 offen sc1
    s_waitcnt vmcnt(0)
    v_accvgpr_write_b32 a0, 0
    v_accvgpr_write_b32 a1, 0
    v_accvgpr_write_b32 a2, 0
    v_accvgpr_write_b32 a3, 0
    v_accvgpr_write_b32 a4, 0
    v_accvgpr_write_b32 a5, 0
    v_accvgpr_write_b32 a6, 0
    v_accvgpr_write_b32 a7, 0
    v_accvgpr_write_b32 a8, 0
    v_accvgpr_write_b32 a9, 0
    v_accvgpr_write_b32 a10, 0
    v_accvgpr_write_b32 a11, 0
    v_accvgpr_write_b32 a12, 0
    v_accvgpr_write_b32 a13, 0
    v_accvgpr_write_b32 a14, 0
    v_accvgpr_write_b32 a15, 0
    v_accvgpr_write_b32 a16, 0
    v_accvgpr_write_b32 a17, 0
    v_accvgpr_write_b32 a18, 0
    v_accvgpr_write_b32 a19, 0
    v_accvgpr_write_b32 a20, 0
    v_accvgpr_write_b32 a21, 0
    v_accvgpr_write_b32 a22, 0
    v_accvgpr_write_b32 a23, 0
    v_accvgpr_write_b32 a24, 0
    v_accvgpr_write_b32 a25, 0
    v_accvgpr_write_b32 a26, 0
    v_accvgpr_write_b32 a27, 0
    v_accvgpr_write_b32 a28, 0
    v_accvgpr_write_b32 a29, 0
    v_accvgpr_write_b32 a30, 0
    v_accvgpr_write_b32 a31, 0
    v_accvgpr_write_b32 a32, 0
    v_accvgpr_write_b32 a33, 0
    v_accvgpr_write_b32 a34, 0
    v_accvgpr_write_b32 a35, 0
    v_accvgpr_write_b32 a36, 0
    v_accvgpr_write_b32 a37, 0
    v_accvgpr_write_b32 a38, 0
    v_accvgpr_write_b32 a39, 0
    v_accvgpr_write_b32 a40, 0
    v_accvgpr_write_b32 a41, 0
    v_accvgpr_write_b32 a42, 0
    v_accvgpr_write_b32 a43, 0
    v_accvgpr_write_b32 a44, 0
    v_accvgpr_write_b32 a45, 0
    v_accvgpr_write_b32 a46, 0
    v_accvgpr_write_b32 a47, 0
    v_accvgpr_write_b32 a48, 0
    v_accvgpr_write_b32 a49, 0
    v_accvgpr_write_b32 a50, 0
    v_accvgpr_write_b32 a51, 0
    v_accvgpr_write_b32 a52, 0
    v_accvgpr_write_b32 a53, 0
    v_accvgpr_write_b32 a54, 0
    v_accvgpr_write_b32 a55, 0
    v_accvgpr_write_b32 a56, 0
    v_accvgpr_write_b32 a57, 0
    v_accvgpr_write_b32 a58, 0
    v_accvgpr_write_b32 a59, 0
    v_accvgpr_write_b32 a60, 0
    v_accvgpr_write_b32 a61, 0
    v_accvgpr_write_b32 a62, 0
    v_accvgpr_write_b32 a63, 0
    v_mov_b32 v11, 148864
    v_mov_b32 v12, 1
    s_add_u32 s99, s99, 4
    s_waitcnt lgkmcnt(0)
    s_mov_b64 exec, 1
    ds_add_u32 v11, v12 offset:12
    s_mov_b64 exec, -1
    s_mov_b32 s98, 2097152
LSPIN_37:
    ds_read_b32 v12, v11 offset:12
    s_waitcnt lgkmcnt(0)
    v_cmp_le_u16 vcc, s99, v12
    s_cbranch_vccz RETRY_38
    s_branch L_RESTART
RETRY_2:
    s_mov_b64 exec, vcc
    s_sleep 8
    s_sub_u32 s98, s98, 1
    s_cbranch_scc0 POLL_1
    s_endpgm
RETRY_4:
    s_sleep 0
    s_sub_u32 s98, s98, 1
    s_cbranch_scc0 LSPIN_3
    s_endpgm
RETRY_6:
    s_sleep 0
    s_sub_u32 s98, s98, 1
    s_cbranch_scc0 LSPIN_5
    s_endpgm
RETRY_8:
    s_sleep 0
    s_sub_u32 s98, s98, 1
    s_cbranch_scc0 LSPIN_7
    s_endpgm
RETRY_10:
    s_sleep 4
    s_sub_u32 s98, s98, 1
    s_cbranch_scc0 LSPIN_9
    s_endpgm
RETRY_12:
    s_sleep 4
    s_sub_u32 s98, s98, 1
    s_cbranch_scc0 LSPIN_11
    s_endpgm
RETRY_14:
    s_mov_b64 exec, vcc
    s_sleep 8
    s_sub_u32 s98, s98, 1
    s_cbranch_scc0 POLL_13
    s_endpgm
RETRY_16:
    s_mov_b64 exec, vcc
    s_sleep 12
    s_sub_u32 s98, s98, 1
    s_cbranch_scc0 FPOLL_15
    s_endpgm
RETRY_18:
    s_mov_b64 exec, vcc
    s_sleep 4
    s_sub_u32 s98, s98, 1
    s_cbranch_scc0 POLL_17
    s_endpgm
RETRY_20:
    s_mov_b64 exec, vcc
    s_sleep 16
    s_sub_u32 s98, s98, 1
    s_cbranch_scc0 POLL_19
    s_endpgm
RETRY_22:
    s_mov_b64 exec, vcc
    s_sleep 16
    s_sub_u32 s98, s98, 1
    s_cbranch_scc0 POLL_21
    s_endpgm
RETRY_24:
    s_mov_b64 exec, vcc
    s_sleep 16
    s_sub_u32 s98, s98, 1
    s_cbranch_scc0 POLL_23
    s_endpgm
RETRY_26:
    s_mov_b64 exec, vcc
    s_sleep 16
    s_sub_u32 s98, s98, 1
    s_cbranch_scc0 POLL_25
    s_endpgm
RETRY_28:
    s_mov_b64 exec, vcc
    s_sleep 4
    s_sub_u32 s98, s98, 1
    s_cbranch_scc0 POLL_27
    s_endpgm
L_OS_FAR:
    buffer_store_dwordx4 v[64:67], v2, s[44:47], s12 offen offset:0 sc1
    buffer_store_dwordx4 v[68:71], v2, s[44:47], s12 offen offset:1024 sc1
    s_branch L_OS_BACK
RETRY_30:
    s_sleep 0
    s_sub_u32 s98, s98, 1
    s_cbranch_scc0 LSPIN_29
    s_endpgm
RETRY_32:
    s_mov_b64 exec, vcc
    s_sleep 4
    s_sub_u32 s98, s98, 1
    s_cbranch_scc0 POLL_31
    s_endpgm
RETRY_34:
    s_sleep 0
    s_sub_u32 s98, s98, 1
    s_cbranch_scc0 LSPIN_33
    s_endpgm
RETRY_36:
    s_sleep 0
    s_sub_u32 s98, s98, 1
    s_cbranch_scc0 LSPIN_35
    s_endpgm
RETRY_38:
    s_sleep 0
    s_sub_u32 s98, s98, 1
    s_cbranch_scc0 LSPIN_37
    s_endpgm
L_CODE_END:

.section .rodata,"a"
.p2align 6
.amdhsa_kernel gated_mix__ssm_conv_h3__mha_block__prompt_kernel
  .amdhsa_next_free_vgpr 256
  .amdhsa_next_free_sgpr 102
  .amdhsa_accum_offset 192
  .amdhsa_group_segment_fixed_size 0
  .amdhsa_kernarg_size 104
  .amdhsa_user_sgpr_count 2
  .amdhsa_user_sgpr_kernarg_segment_ptr 1
  .amdhsa_system_sgpr_workgroup_id_x 1
.end_amdhsa_kernel
```
